```python
import torch

def _softmax(x, axis=-1):
    return torch.softmax(x, dim=axis)
def _gelu(x):
    return torch.nn.functional.gelu(x, approximate="tanh")
def _silu(x):
    return torch.nn.functional.silu(x)
def _sigmoid(x):
    return torch.sigmoid(x)
def _layernorm(x, axis=-1, eps=1e-5):
    m = x.mean(dim=axis, keepdim=True)
    v = x.var(dim=axis, keepdim=True, unbiased=False)
    return (x - m) / torch.sqrt(v + eps)
def _scatter_add(tgt, idx, src, axis=0):
    return tgt.clone().index_add_(axis, idx, src)
def _segment_sum(src, seg, n):
    out = torch.zeros((n,) + src.shape[1:], dtype=src.dtype)
    return out.index_add_(0, seg, src)
def _pad(x, pw):
    flat = tuple(v for pair in reversed(pw) for v in pair)
    return torch.nn.functional.pad(x, flat)

kernel_name = 'gated_mix__grouped_kv_mqa__ssm_conv_h3__prompt'

def setup_inputs():

    _w = (lambda a: (lambda t: t.to(torch.bfloat16) if t.is_floating_point() else t)(torch.as_tensor(a)))
    def _A_setup():
        B, S, D, H = 1, 2048, 576, 32
        Dh = D // H
        return {
            "x": _w((lambda *s: torch.randn(*s, dtype=torch.bfloat16) * 0.05)(B, S, D)),
            "wq": _w((lambda *s: torch.randn(*s, dtype=torch.bfloat16) * 0.8)(D, H * Dh)),
            "wk": _w((lambda *s: torch.randn(*s, dtype=torch.bfloat16) * 0.8)(D, Dh)),
            "wv": _w((lambda *s: torch.randn(*s, dtype=torch.bfloat16) * 0.05)(D, Dh)),
            "wo": _w((lambda *s: torch.randn(*s, dtype=torch.bfloat16) * 0.05)(H * Dh, D)),
        }
    _A_in = _A_setup()

    def _B_setup():
        B, S, D = 1, 2048, 576
        ks = 4
        return {
            "q": _w((lambda *s: torch.randn(*s, dtype=torch.bfloat16) * 0.05)(B, S, D)),
            "k": _w((lambda *s: torch.randn(*s, dtype=torch.bfloat16) * 0.4)(B, S, D)),
            "v": _w((lambda *s: torch.randn(*s, dtype=torch.bfloat16) * 0.2)(B, S, D)),
            "shift_k": _w((lambda *s: torch.randn(*s, dtype=torch.bfloat16) * 0.4)(D, ks) * 0.5),
            "ssm_k": _w((lambda *s: torch.randn(*s, dtype=torch.bfloat16) * 0.4)(D, S) * (1.0 / S ** 0.5)),
            "ssm_D": _w((lambda *s: torch.randn(*s, dtype=torch.bfloat16) * 0.2)(D)),
        }
    _B_in = _B_setup()

    return {
        "A_x": _A_in["x"],
        "A_wq": _A_in["wq"],
        "A_wk": _A_in["wk"],
        "A_wv": _A_in["wv"],
        "A_wo": _A_in["wo"],
        "B_q": _B_in["q"],
        "B_k": _B_in["k"],
        "B_v": _B_in["v"],
        "B_shift_k": _B_in["shift_k"],
        "B_ssm_k": _B_in["ssm_k"],
        "B_ssm_D": _B_in["ssm_D"],
        "gate_w": _w((lambda *s: torch.randn(*s, dtype=torch.bfloat16) * 0.05)(576) * 16.0),
    }

def reference(A_x, A_wq, A_wk, A_wv, A_wo, B_q, B_k, B_v, B_shift_k, B_ssm_k, B_ssm_D, gate_w):
    def _A_ref(x, wq, wk, wv, wo):
        B, S, D = x.shape
        H = 32
        Dh = D // H
        q = (lambda x, *d: x.permute(*d))((x @ wq).reshape(B, S, H, Dh), 0, 2, 1, 3)
        k = x @ wk
        v = x @ wv
        scores = torch.einsum("bhqd,bkd->bhqk", q, k) * (Dh ** -0.5)
        p = _softmax(scores, axis=-1)
        o = torch.einsum("bhqk,bkd->bhqd", p, v)
        return (lambda x, *d: x.permute(*d))(o, 0, 2, 1, 3).reshape(B, S, H * Dh) @ wo

    def _B_ref(q, k, v, shift_k, ssm_k, ssm_D):
        B, S, D = q.shape
        ks = shift_k.shape[-1]
        k_pad = _pad(k, ((0, 0), (ks - 1, 0), (0, 0)))
        k_shift = torch.zeros_like(k)
        for t in range(ks):
            k_shift = k_shift + k_pad[:, t:t + S, :] * shift_k[:, ks - 1 - t][None, None, :]
        kv = k_shift * v
        L = 2 * S
        kv_pad = _pad(kv, ((0, 0), (0, S), (0, 0)))
        kf_pad = _pad(ssm_k, ((0, 0), (0, S)))
        kv_f = (lambda x, axes=(-2,-1): torch.fft.rfft2(x.float(), dim=axes))(kv_pad[:, None, :, :], axes=(1, 2))
        kf_f = (lambda x, axes=(-2,-1): torch.fft.rfft2(x.float(), dim=axes))(kf_pad[:, None, :], axes=(1, 2))
        kf_f = (lambda x, *d: x.permute(*d))(kf_f, 1, 2, 0)
        y_f = kv_f * kf_f[None, :, :, :]
        y = (lambda x, s, axes=(-2,-1): torch.fft.irfft2(x, s=s, dim=axes).to(torch.bfloat16))(y_f, (1, L), axes=(1, 2))[:, 0, :S, :]
        y = y + kv * ssm_D[None, None, :]
        return q * y

    x = A_x
    g = _sigmoid((x * gate_w).sum(-1, keepdims=True))
    a = _A_ref(x, A_wq, A_wk, A_wv, A_wo)
    b = _B_ref(x, B_k, B_v, B_shift_k, B_ssm_k, B_ssm_D)
    return g * a + (1 - g) * b
```

```asm
; @launch grid=(256,1,1) block=(768,1,1) lds=163840
.amdgcn_target "amdgcn-amd-amdhsa--gfx950"
.text
.globl gated_mix__grouped_kv_mqa__ssm_conv_h3__prompt_kernel
.p2align 8
.type gated_mix__grouped_kv_mqa__ssm_conv_h3__prompt_kernel,@function
gated_mix__grouped_kv_mqa__ssm_conv_h3__prompt_kernel:
    s_cmp_ge_u32 s2, 256
    s_cbranch_scc1 L_end
    s_load_dwordx8 s[64:71], s[0:1], 0
    s_getpc_b64 s[62:63]
L_pcref:
    s_lshr_b32 s29, s2, 3
    s_lshl_b32 s29, s29, 10
    s_min_u32 s29, s29, L_code_end - L_pcref - 1024
    s_add_u32 s62, s62, s29
    s_addc_u32 s63, s63, 0
    v_lshlrev_b32 v12, 4, v0
    v_mov_b32 v13, s63
    v_add_co_u32 v12, vcc, s62, v12
    s_nop 1
    v_addc_co_u32 v13, vcc, 0, v13, vcc
    v_cmp_gt_u32 vcc, 64, v0
    s_and_saveexec_b64 s[30:31], vcc
    s_cbranch_execz L_nopf
    global_load_dwordx4 v[156:159], v[12:13], off
L_nopf:
    s_mov_b64 exec, s[30:31]
    s_load_dwordx2 s[72:73], s[0:1], 88
    s_load_dwordx2 s[4:5], s[0:1], 112
    s_load_dwordx2 s[40:41], s[0:1], 104
    s_load_dwordx2 s[8:9], s[0:1], 96
    s_load_dwordx2 s[10:11], s[0:1], 32
    s_load_dwordx2 s[42:43], s[0:1], 80
    s_memrealtime s[98:99]
    v_lshrrev_b32 v11, 6, v0
    v_and_b32 v1, 63, v0
    v_readfirstlane_b32 s24, v11
    s_and_b32 s29, s2, 7
    s_lshr_b32 s32, s2, 3
    s_and_b32 s26, s32, 7
    s_lshr_b32 s32, s32, 3
    s_lshl_b32 s25, s29, 2
    s_add_u32 s25, s25, s32
    s_mov_b32 s30, 0
    s_mov_b32 s31, -1
    s_lshr_b32 s36, s24, 2
    s_and_b32 s37, s24, 3
    s_lshl_b32 s37, s37, 1
    s_and_b32 s97, s26, 3
    s_lshl_b32 s29, s25, 1
    s_add_u32 s29, s29, s26
    s_mul_i32 s32, s29, 7282
    s_lshr_b32 s32, s32, 16
    s_mul_i32 s32, s32, 9
    s_sub_u32 s92, s29, s32
    v_lshlrev_b32 v8, 4, v1
    v_lshlrev_b32 v9, 3, v1
    v_mov_b32 v160, 162816
    v_mov_b32 v161, 1
    v_mov_b32 v10, 0
    v_lshrrev_b32 v11, 3, v1
    v_lshrrev_b32 v12, 4, v1
    v_and_b32 v13, 7, v1
    v_xor_b32 v13, v13, v12
    v_mul_u32_u24 v11, 1152, v11
    v_lshl_add_u32 v16, v13, 4, v11
    v_xor_b32 v17, 64, v16
    v_add_u32 v17, 9216, v17
    v_lshrrev_b32 v11, 2, v1
    v_and_b32 v12, 3, v1
    v_mul_u32_u24 v11, 36, v11
    v_lshl_add_u32 v21, v12, 4, v11
    s_lshl_b32 s29, s25, 2
    s_add_u32 s32, s29, s24
    s_mul_i32 s74, s32, 18432
    s_mul_i32 s75, s26, 144
    s_waitcnt lgkmcnt(0)
    s_mov_b32 s76, s64
    s_and_b32 s77, s65, 0xffff
    s_mov_b32 s78, 2359296
    s_mov_b32 s79, 0x00020000
    s_cmp_lt_u32 s26, 4
    s_cselect_b32 s29, s68, s70
    s_cselect_b32 s32, s69, s71
    s_mov_b32 s84, s29
    s_and_b32 s85, s32, 0xffff
    s_mov_b32 s86, 20736
    s_mov_b32 s87, 0x00020000
    s_mov_b32 s88, s72
    s_and_b32 s89, s73, 0xffff
    s_mov_b32 s90, 1152
    s_mov_b32 s91, 0x00020000
    s_mov_b32 s80, s66
    s_and_b32 s81, s67, 0xffff
    s_mov_b32 s82, 663552
    s_mov_b32 s83, 0x00020000
    s_mov_b32 s12, s4
    s_and_b32 s13, s5, 0xffff
    s_mov_b32 s14, 12156928
    s_mov_b32 s15, 0x00020000
    s_mov_b32 s16, s4
    s_and_b32 s17, s5, 0xffff
    s_mov_b32 s18, 12156928
    s_mov_b32 s19, 0x00020000
    s_lshr_b32 s72, s25, 2
    s_load_dwordx8 s[64:71], s[0:1], 48
    s_cmp_lt_u32 s24, 4
    s_cbranch_scc1 L_lo
    s_cmp_lt_u32 s24, 8
    s_cbranch_scc1 L_mid
    s_cmp_eq_u32 s24, 8
    s_cbranch_scc1 L_w8
    s_setprio 3
    s_sub_u32 s33, s24, 9
    s_mul_i32 s33, s33, 3
    s_add_u32 s94, s92, s33
    s_sub_u32 s29, s94, 9
    s_cmp_ge_u32 s94, 9
    s_cselect_b32 s94, s29, s94
    s_lshl_b32 s29, s25, 2
    s_add_u32 s29, s29, s97
    s_mul_i32 s96, s29, 18432
    s_lshl_b32 s39, s33, 12
    s_add_u32 s39, s39, 121856
    s_mov_b32 s95, s39
    v_lshlrev_b32 v11, 1, v1
    s_add_u32 s100, s33, 0
    s_mul_i32 s29, s100, 17408
    s_lshl_b32 s32, s97, 11
    s_add_u32 s29, s29, s32
    s_lshl_b32 s32, s100, 11
    s_add_u32 s32, s32, 144384
    s_cmp_lt_u32 s100, 7
    s_cselect_b32 s20, s29, s32
    s_lshl_b32 s32, s94, 7
    buffer_load_ushort v30, v11, s[88:91], s32 offen
    s_add_u32 s32, s32, s96
    s_mov_b32 m0, s20
    s_nop 0
    buffer_load_dwordx4 v16, s[76:79], s32 offen lds
    s_add_u32 s29, s20, 1024
    s_mov_b32 m0, s29
    s_nop 0
    buffer_load_dwordx4 v17, s[76:79], s32 offen lds
    s_mul_i32 s32, s94, 2304
    s_mov_b32 exec_lo, 0x77777777
    s_mov_b32 exec_hi, 0x77777777
    s_mov_b32 m0, s39
    s_nop 0
    buffer_load_dwordx4 v21, s[84:87], s32 offen lds
    s_add_u32 s39, s39, 1024
    s_add_u32 s32, s32, 576
    s_mov_b32 m0, s39
    s_nop 0
    buffer_load_dwordx4 v21, s[84:87], s32 offen lds
    s_add_u32 s39, s39, 1024
    s_add_u32 s32, s32, 576
    s_mov_b32 m0, s39
    s_nop 0
    buffer_load_dwordx4 v21, s[84:87], s32 offen lds
    s_add_u32 s39, s39, 1024
    s_add_u32 s32, s32, 576
    s_mov_b32 m0, s39
    s_nop 0
    buffer_load_dwordx4 v21, s[84:87], s32 offen lds
    s_add_u32 s39, s39, 1024
    s_add_u32 s32, s32, 576
    s_mov_b64 exec, -1
    s_add_u32 s94, s94, 1
    s_cmp_eq_u32 s94, 9
    s_cselect_b32 s94, 0, s94
    s_add_u32 s100, s33, 1
    s_mul_i32 s29, s100, 17408
    s_lshl_b32 s32, s97, 11
    s_add_u32 s29, s29, s32
    s_lshl_b32 s32, s100, 11
    s_add_u32 s32, s32, 144384
    s_cmp_lt_u32 s100, 7
    s_cselect_b32 s21, s29, s32
    s_lshl_b32 s32, s94, 7
    buffer_load_ushort v31, v11, s[88:91], s32 offen
    s_add_u32 s32, s32, s96
    s_mov_b32 m0, s21
    s_nop 0
    buffer_load_dwordx4 v16, s[76:79], s32 offen lds
    s_add_u32 s29, s21, 1024
    s_mov_b32 m0, s29
    s_nop 0
    buffer_load_dwordx4 v17, s[76:79], s32 offen lds
    s_mul_i32 s32, s94, 2304
    s_mov_b32 exec_lo, 0x77777777
    s_mov_b32 exec_hi, 0x77777777
    s_mov_b32 m0, s39
    s_nop 0
    buffer_load_dwordx4 v21, s[84:87], s32 offen lds
    s_add_u32 s39, s39, 1024
    s_add_u32 s32, s32, 576
    s_mov_b32 m0, s39
    s_nop 0
    buffer_load_dwordx4 v21, s[84:87], s32 offen lds
    s_add_u32 s39, s39, 1024
    s_add_u32 s32, s32, 576
    s_mov_b32 m0, s39
    s_nop 0
    buffer_load_dwordx4 v21, s[84:87], s32 offen lds
    s_add_u32 s39, s39, 1024
    s_add_u32 s32, s32, 576
    s_mov_b32 m0, s39
    s_nop 0
    buffer_load_dwordx4 v21, s[84:87], s32 offen lds
    s_add_u32 s39, s39, 1024
    s_add_u32 s32, s32, 576
    s_mov_b64 exec, -1
    s_add_u32 s94, s94, 1
    s_cmp_eq_u32 s94, 9
    s_cselect_b32 s94, 0, s94
    s_add_u32 s100, s33, 2
    s_mul_i32 s29, s100, 17408
    s_lshl_b32 s32, s97, 11
    s_add_u32 s29, s29, s32
    s_lshl_b32 s32, s100, 11
    s_add_u32 s32, s32, 144384
    s_cmp_lt_u32 s100, 7
    s_cselect_b32 s22, s29, s32
    s_lshl_b32 s32, s94, 7
    buffer_load_ushort v32, v11, s[88:91], s32 offen
    s_add_u32 s32, s32, s96
    s_mov_b32 m0, s22
    s_nop 0
    buffer_load_dwordx4 v16, s[76:79], s32 offen lds
    s_add_u32 s29, s22, 1024
    s_mov_b32 m0, s29
    s_nop 0
    buffer_load_dwordx4 v17, s[76:79], s32 offen lds
    s_mul_i32 s32, s94, 2304
    s_mov_b32 exec_lo, 0x77777777
    s_mov_b32 exec_hi, 0x77777777
    s_mov_b32 m0, s39
    s_nop 0
    buffer_load_dwordx4 v21, s[84:87], s32 offen lds
    s_add_u32 s39, s39, 1024
    s_add_u32 s32, s32, 576
    s_mov_b32 m0, s39
    s_nop 0
    buffer_load_dwordx4 v21, s[84:87], s32 offen lds
    s_add_u32 s39, s39, 1024
    s_add_u32 s32, s32, 576
    s_mov_b32 m0, s39
    s_nop 0
    buffer_load_dwordx4 v21, s[84:87], s32 offen lds
    s_add_u32 s39, s39, 1024
    s_add_u32 s32, s32, 576
    s_mov_b32 m0, s39
    s_nop 0
    buffer_load_dwordx4 v21, s[84:87], s32 offen lds
    s_add_u32 s39, s39, 1024
    s_add_u32 s32, s32, 576
    s_mov_b64 exec, -1
    s_add_u32 s94, s94, 1
    s_cmp_eq_u32 s94, 9
    s_cselect_b32 s94, 0, s94
    s_barrier
    s_call_b64 s[62:63], L_hconsts
    v_lshrrev_b32 v11, 4, v1
    v_bfe_u32 v13, v1, 2, 2
    v_and_b32 v14, 3, v1
    v_lshl_add_u32 v12, v11, 3, v13
    v_lshlrev_b32 v12, 6, v12
    v_lshl_add_u32 v22, v14, 3, v12
    v_add_u32 v22, s95, v22
    v_and_b32 v12, 15, v1
    v_lshrrev_b32 v13, 1, v12
    v_xor_b32 v13, v13, v11
    v_lshlrev_b32 v15, 7, v12
    v_lshl_add_u32 v23, v13, 4, v15
    v_add_u32 v34, s20, v23
    v_xor_b32 v35, 64, v34
    v_add_u32 v36, s21, v23
    v_xor_b32 v37, 64, v36
    v_add_u32 v38, s22, v23
    v_xor_b32 v39, 64, v38
    v_mov_b32 v72, 0
    v_mov_b32 v73, 0
    v_mov_b32 v74, 0
    v_mov_b32 v75, 0
    v_mov_b32 v76, 0
    v_mov_b32 v77, 0
    v_mov_b32 v78, 0
    v_mov_b32 v79, 0
    v_lshlrev_b32 v11, 6, v1
    v_add_u32 v11, s95, v11
    s_waitcnt vmcnt(0)
    ds_write_b16 v11, v30 offset:48
    ds_write_b16 v11, v31 offset:4144
    ds_write_b16 v11, v32 offset:8240
    ds_read_b128 v[84:87], v34
    ds_read_b64_tr_b16 v[88:89], v22 offset:0
    ds_read_b64_tr_b16 v[90:91], v22 offset:256
    ds_read_b64_tr_b16 v[92:93], v22 offset:32
    ds_read_b64_tr_b16 v[94:95], v22 offset:288
    ds_read_b128 v[96:99], v35
    ds_read_b64_tr_b16 v[100:101], v22 offset:2048
    ds_read_b64_tr_b16 v[102:103], v22 offset:2304
    ds_read_b64_tr_b16 v[104:105], v22 offset:2080
    ds_read_b64_tr_b16 v[106:107], v22 offset:2336
    s_waitcnt lgkmcnt(5)
    ds_read_b128 v[108:111], v36
    ds_read_b64_tr_b16 v[112:113], v22 offset:4096
    ds_read_b64_tr_b16 v[114:115], v22 offset:4352
    ds_read_b64_tr_b16 v[116:117], v22 offset:4128
    ds_read_b64_tr_b16 v[118:119], v22 offset:4384
    ds_read_b128 v[120:123], v37
    ds_read_b64_tr_b16 v[124:125], v22 offset:6144
    ds_read_b64_tr_b16 v[126:127], v22 offset:6400
    ds_read_b64_tr_b16 v[128:129], v22 offset:6176
    ds_read_b64_tr_b16 v[130:131], v22 offset:6432
    s_waitcnt lgkmcnt(5)
    ds_read_b128 v[132:135], v38
    ds_read_b64_tr_b16 v[136:137], v22 offset:8192
    ds_read_b64_tr_b16 v[138:139], v22 offset:8448
    ds_read_b64_tr_b16 v[140:141], v22 offset:8224
    ds_read_b64_tr_b16 v[142:143], v22 offset:8480
    ds_read_b128 v[144:147], v39
    ds_read_b64_tr_b16 v[148:149], v22 offset:10240
    ds_read_b64_tr_b16 v[150:151], v22 offset:10496
    ds_read_b64_tr_b16 v[152:153], v22 offset:10272
    ds_read_b64_tr_b16 v[154:155], v22 offset:10528
L_kv_0:
    s_cmp_ge_u32 s26, 4
    s_cbranch_scc1 L_kv_1
    v_mfma_f32_16x16x32_bf16 v[72:75], v[88:91], v[84:87], v[72:75]
    v_mfma_f32_16x16x32_bf16 v[76:79], v[92:95], v[84:87], v[76:79]
    v_mfma_f32_16x16x32_bf16 v[72:75], v[100:103], v[96:99], v[72:75]
    v_mfma_f32_16x16x32_bf16 v[76:79], v[104:107], v[96:99], v[76:79]
    v_mfma_f32_16x16x32_bf16 v[72:75], v[112:115], v[108:111], v[72:75]
    v_mfma_f32_16x16x32_bf16 v[76:79], v[116:119], v[108:111], v[76:79]
    s_waitcnt lgkmcnt(10)
    v_mfma_f32_16x16x32_bf16 v[72:75], v[124:127], v[120:123], v[72:75]
    v_mfma_f32_16x16x32_bf16 v[76:79], v[128:131], v[120:123], v[76:79]
    s_waitcnt lgkmcnt(5)
    v_mfma_f32_16x16x32_bf16 v[72:75], v[136:139], v[132:135], v[72:75]
    v_mfma_f32_16x16x32_bf16 v[76:79], v[140:143], v[132:135], v[76:79]
    s_waitcnt lgkmcnt(0)
    v_mfma_f32_16x16x32_bf16 v[72:75], v[148:151], v[144:147], v[72:75]
    v_mfma_f32_16x16x32_bf16 v[76:79], v[152:155], v[144:147], v[76:79]
    s_branch L_kv_j
L_kv_1:
    v_mfma_f32_16x16x32_bf16 v[72:75], v[84:87], v[88:91], v[72:75]
    v_mfma_f32_16x16x32_bf16 v[76:79], v[84:87], v[92:95], v[76:79]
    v_mfma_f32_16x16x32_bf16 v[72:75], v[96:99], v[100:103], v[72:75]
    v_mfma_f32_16x16x32_bf16 v[76:79], v[96:99], v[104:107], v[76:79]
    v_mfma_f32_16x16x32_bf16 v[72:75], v[108:111], v[112:115], v[72:75]
    v_mfma_f32_16x16x32_bf16 v[76:79], v[108:111], v[116:119], v[76:79]
    s_waitcnt lgkmcnt(10)
    v_mfma_f32_16x16x32_bf16 v[72:75], v[120:123], v[124:127], v[72:75]
    v_mfma_f32_16x16x32_bf16 v[76:79], v[120:123], v[128:131], v[76:79]
    s_waitcnt lgkmcnt(5)
    v_mfma_f32_16x16x32_bf16 v[72:75], v[132:135], v[136:139], v[72:75]
    v_mfma_f32_16x16x32_bf16 v[76:79], v[132:135], v[140:143], v[76:79]
    s_waitcnt lgkmcnt(0)
    v_mfma_f32_16x16x32_bf16 v[72:75], v[144:147], v[148:151], v[72:75]
    v_mfma_f32_16x16x32_bf16 v[76:79], v[144:147], v[152:155], v[76:79]
L_kv_j:
    v_add_u32 v11, s95, v8
    s_nop 6
    s_cmp_eq_u32 s24, 9
    s_cbranch_scc1 L_kv_fin
    ds_write_b128 v11, v[72:75]
    ds_write_b128 v11, v[76:79] offset:1024
    s_waitcnt lgkmcnt(0)
    s_mov_b64 exec, 1
    ds_add_u32 v160, v161 offset:0
    s_mov_b64 exec, -1
    s_setprio 0
    s_branch L_q_t2
L_kv_fin:
    s_lshl_b32 s95, s25, 1
    s_lshr_b32 s29, s97, 1
    s_add_u32 s95, s95, s29
    s_lshr_b32 s32, s95, 3
    s_mul_i32 s32, s32, 19456
    s_add_u32 s32, s32, 0
    s_and_b32 s29, s95, 7
    s_and_b32 s96, s97, 1
    s_mov_b32 s93, 0
    s_branch L_cwe_3
L_cw_1:
    s_sleep 1
L_cwe_3:
    ds_read_b32 v15, v160 offset:0
    s_add_u32 s93, s93, 1
    s_waitcnt lgkmcnt(0)
    v_readfirstlane_b32 s100, v15
    s_cmp_ge_u32 s93, 1280000
    s_cbranch_scc1 L_cwd_2
    s_cmp_lt_u32 s100, 2
    s_cbranch_scc1 L_cw_1
L_cwd_2:
    ds_read_b128 v[40:43], v11 offset:12288
    ds_read_b128 v[44:47], v11 offset:13312
    ds_read_b128 v[48:51], v11 offset:24576
    ds_read_b128 v[52:55], v11 offset:25600
    v_and_b32 v11, 15, v1
    v_bfe_u32 v12, v1, 4, 1
    v_lshrrev_b32 v13, 5, v1
    s_waitcnt lgkmcnt(0)
    s_mov_b64 exec, 1
    ds_add_u32 v160, v161 offset:4
    s_mov_b64 exec, -1
    v_add_f32 v72, v72, v40
    v_add_f32 v73, v73, v41
    v_add_f32 v74, v74, v42
    v_add_f32 v75, v75, v43
    v_add_f32 v76, v76, v44
    v_add_f32 v77, v77, v45
    v_add_f32 v78, v78, v46
    v_add_f32 v79, v79, v47
    v_add_f32 v72, v72, v48
    v_add_f32 v73, v73, v49
    v_add_f32 v74, v74, v50
    v_add_f32 v75, v75, v51
    v_add_f32 v76, v76, v52
    v_add_f32 v77, v77, v53
    v_add_f32 v78, v78, v54
    v_add_f32 v79, v79, v55
    v_cvt_pk_bf16_f32 v32, v72, v73
    v_cvt_pk_bf16_f32 v33, v74, v75
    v_cvt_pk_bf16_f32 v34, v76, v77
    v_cvt_pk_bf16_f32 v35, v78, v79
    s_cmp_ge_u32 s26, 4
    s_cbranch_scc1 L_st_v
    v_lshlrev_b32 v14, 4, v11
    v_lshl_add_u32 v14, v13, 9, v14
    v_lshl_add_u32 v14, v12, 3, v14
    s_lshl_b32 s33, s29, 10
    s_add_u32 s33, s33, s32
    s_lshl_b32 s100, s96, 8
    s_add_u32 s33, s33, s100
    buffer_store_dwordx2 v[32:33], v14, s[12:15], s33 offen sc1
    s_lshr_b32 s33, s29, 1
    s_lshl_b32 s33, s33, 8
    s_and_b32 s29, s29, 1
    s_lshl_b32 s29, s29, 2
    s_add_u32 s33, s33, s29
    s_add_u32 s33, s33, s32
    s_lshl_b32 s100, s96, 7
    s_add_u32 s33, s33, s100
    s_add_u32 s33, s33, 8192
    s_mov_b32 exec_lo, 0xffff
    s_mov_b32 exec_hi, 0
    buffer_store_dword v34, v9, s[12:15], s33 offen sc1
    s_mov_b32 exec_lo, 0
    s_mov_b32 exec_hi, 0xffff
    v_lshlrev_b32 v14, 16, v34
    v_mul_f32 v14, 3216550459, v14
    v_exp_f32 v14, v14
    s_nop 0
    v_add_f32 v14, 1.0, v14
    v_rcp_f32 v14, v14
    s_nop 0
    v_cvt_pk_bf16_f32 v14, v14, v14
    v_and_b32 v14, 0xffff0000, v14
    v_lshlrev_b32 v15, 2, v11
    s_lshl_b32 s33, s95, 7
    s_lshl_b32 s100, s96, 6
    s_add_u32 s33, s33, s100
    s_add_u32 s33, s33, 7340032
    buffer_store_dword v14, v15, s[12:15], s33 offen sc1
    s_mov_b64 exec, -1
    s_branch L_kv_pub
L_st_v:
    v_cmp_eq_u32 vcc, 2, v11
    v_mov_b32 v14, 0x3f803f80
    s_nop 0
    v_cndmask_b32 v34, v34, v14, vcc
    v_cndmask_b32 v35, v35, v14, vcc
    v_cmp_eq_u32 vcc, 3, v11
    s_nop 1
    v_cndmask_b32 v34, v34, 0, vcc
    v_cndmask_b32 v35, v35, 0, vcc
    v_mul_u32_u24 v12, 320, v12
    v_lshl_add_u32 v12, v11, 4, v12
    v_lshl_add_u32 v12, v13, 3, v12
    s_lshl_b32 s29, s29, 1
    s_add_u32 s29, s29, s96
    s_mul_i32 s29, s29, 640
    s_add_u32 s29, s29, s32
    s_add_u32 s29, s29, 9216
    buffer_store_dwordx2 v[32:33], v12, s[12:15], s29 offen sc1
    s_mov_b32 exec_lo, 0x000f000f
    s_mov_b32 exec_hi, 0x000f000f
    buffer_store_dwordx2 v[34:35], v12, s[12:15], s29 offen offset:256 sc1
    s_mov_b64 exec, -1
L_kv_pub:
    s_load_dwordx2 s[6:7], s[40:41], 0
    s_waitcnt lgkmcnt(0)
    v_mov_b32 v162, s6
    v_mov_b32 v163, s7
    s_mov_b32 s93, 0
    v_mov_b32 v15, 0
L_tg_4:
    v_cmp_eq_u32 vcc, 0, v162
    s_nop 4
    s_cbranch_vccz L_tgd_5
    s_add_u32 s93, s93, 1
    s_cmp_ge_u32 s93, 20000
    s_cbranch_scc1 L_tgd_5
    s_sleep 4
    global_load_dwordx2 v[162:163], v15, s[40:41] sc1
    s_waitcnt vmcnt(0)
    s_branch L_tg_4
L_tgd_5:
    s_lshl_b32 s95, s25, 3
    s_add_u32 s95, s95, s26
    s_lshl_b32 s95, s95, 6
    s_add_u32 s95, s95, 262144
    s_waitcnt vmcnt(0)
    s_mov_b64 exec, 3
    buffer_store_dwordx2 v[162:163], v9, s[12:15], s95 offen sc1
    s_mov_b64 exec, -1
    s_setprio 0
    s_mov_b32 s93, 0
    s_branch L_cwe_8
L_cw_6:
    s_sleep 2
L_cwe_8:
    ds_read_b32 v15, v160 offset:28
    s_add_u32 s93, s93, 1
    s_waitcnt lgkmcnt(0)
    v_readfirstlane_b32 s100, v15
    s_cmp_ge_u32 s93, 1280000
    s_cbranch_scc1 L_cwd_7
    s_cmp_lt_u32 s100, 1
    s_cbranch_scc1 L_cw_6
L_cwd_7:
    s_mov_b32 s101, 1
    s_add_u32 s95, s101, s72
    s_and_b32 s95, s95, 7
    s_lshl_b32 s95, s95, 11
    s_add_u32 s95, s95, 262144
    v_and_b32 v11, 31, v1
    v_lshlrev_b32 v11, 6, v11
    s_mov_b32 s93, 0
L_pf_9:
    buffer_load_dwordx2 v[152:153], v11, s[12:15], s95 offen offset:0 sc1
    s_add_u32 s93, s93, 1
    s_waitcnt vmcnt(0)
    v_cmp_ne_u64 vcc, v[152:153], v[162:163]
    s_nop 4
    s_cbranch_vccz L_pfd_10
    s_sleep 20
    s_cmp_lt_u32 s93, 20000
    s_cbranch_scc1 L_pf_9
L_pfd_10:
    s_mov_b32 s33, 0
    s_add_u32 s95, s101, s72
    s_and_b32 s95, s95, 7
    s_mul_i32 s95, s95, 19456
    s_add_u32 s95, s95, 0
    s_and_b32 s96, s101, 3
    s_mul_i32 s96, s96, 19456
    s_lshl_b32 s39, s33, 10
L_p0_11:
    s_add_u32 s32, s39, s96
    s_mov_b32 m0, s32
    s_add_u32 s32, s39, s95
    buffer_load_dwordx4 v8, s[12:15], s32 offen sc1 lds
    s_add_u32 s39, s39, 1024
    s_cmp_lt_u32 s39, 19456
    s_cbranch_scc1 L_p0_11
    s_waitcnt vmcnt(0)
    s_mov_b64 exec, 1
    ds_add_u32 v160, v161 offset:112
    s_mov_b64 exec, -1
    s_branch L_q_done
L_p0help:
    s_mov_b32 s93, 0
    s_branch L_cwe_14
L_cw_12:
    s_sleep 2
L_cwe_14:
    ds_read_b32 v15, v160 offset:28
    s_add_u32 s93, s93, 1
    s_waitcnt lgkmcnt(0)
    v_readfirstlane_b32 s100, v15
    s_cmp_ge_u32 s93, 1280000
    s_cbranch_scc1 L_cwd_13
    s_cmp_lt_u32 s100, 1
    s_cbranch_scc1 L_cw_12
L_cwd_13:
L_p0:
    s_mov_b32 s100, 0
    s_add_u32 s95, s100, s72
    s_and_b32 s95, s95, 7
    s_mul_i32 s95, s95, 19456
    s_add_u32 s95, s95, 0
    s_and_b32 s96, s100, 3
    s_mul_i32 s96, s96, 19456
    s_lshl_b32 s39, s33, 10
L_p0_15:
    s_add_u32 s32, s39, s96
    s_mov_b32 m0, s32
    s_add_u32 s32, s39, s95
    buffer_load_dwordx4 v8, s[12:15], s32 offen sc1 lds
    s_add_u32 s39, s39, 5120
    s_cmp_lt_u32 s39, 19456
    s_cbranch_scc1 L_p0_15
    s_waitcnt vmcnt(0)
    s_branch L_q_add
L_w8:
    v_mov_b32 v11, 0
    v_lshl_add_u32 v12, v1, 2, v160
    ds_write_b32 v12, v11
    s_cmp_lg_u32 s2, 0
    s_cbranch_scc1 L_notag
    s_or_b32 s98, s98, 1
    v_mov_b32 v162, s98
    v_mov_b32 v163, s99
    s_mov_b64 exec, 1
    global_store_dwordx2 v11, v[162:163], s[40:41] sc1
    s_mov_b64 exec, -1
L_notag:
    s_waitcnt lgkmcnt(0)
    s_barrier
    s_call_b64 s[62:63], L_hconsts
    s_mov_b32 s93, 0
    s_branch L_cwe_18
L_cw_16:
    s_sleep 2
L_cwe_18:
    ds_read_b32 v15, v160 offset:92
    s_add_u32 s93, s93, 1
    s_waitcnt lgkmcnt(0)
    v_readfirstlane_b32 s100, v15
    s_cmp_ge_u32 s93, 1280000
    s_cbranch_scc1 L_cwd_17
    s_cmp_lt_u32 s100, 4
    s_cbranch_scc1 L_cw_16
L_cwd_17:
    s_load_dwordx2 s[6:7], s[40:41], 0
    s_waitcnt lgkmcnt(0)
    v_mov_b32 v162, s6
    v_mov_b32 v163, s7
    s_mov_b32 s93, 0
    v_mov_b32 v15, 0
L_tg_19:
    v_cmp_eq_u32 vcc, 0, v162
    s_nop 4
    s_cbranch_vccz L_tgd_20
    s_add_u32 s93, s93, 1
    s_cmp_ge_u32 s93, 20000
    s_cbranch_scc1 L_tgd_20
    s_sleep 4
    global_load_dwordx2 v[162:163], v15, s[40:41] sc1
    s_waitcnt vmcnt(0)
    s_branch L_tg_19
L_tgd_20:
    s_setprio 3
    s_mov_b32 s100, 0
    s_add_u32 s95, s100, s72
    s_and_b32 s95, s95, 7
    s_lshl_b32 s95, s95, 11
    s_add_u32 s95, s95, 262144
    v_and_b32 v11, 31, v1
    v_lshlrev_b32 v11, 6, v11
    s_mov_b32 s93, 0
L_pf_21:
    buffer_load_dwordx2 v[152:153], v11, s[12:15], s95 offen offset:0 sc1
    s_add_u32 s93, s93, 1
    s_waitcnt vmcnt(0)
    v_cmp_ne_u64 vcc, v[152:153], v[162:163]
    s_nop 4
    s_cbranch_vccz L_pfd_22
    s_sleep 8
    s_cmp_lt_u32 s93, 20000
    s_cbranch_scc1 L_pf_21
L_pfd_22:
    s_mov_b32 s93, 0
    s_branch L_cwe_25
L_cw_23:
    s_sleep 1
L_cwe_25:
    ds_read_b32 v15, v160 offset:20
    s_add_u32 s93, s93, 1
    s_waitcnt lgkmcnt(0)
    v_readfirstlane_b32 s100, v15
    s_cmp_ge_u32 s93, 1280000
    s_cbranch_scc1 L_cwd_24
    s_cmp_lt_u32 s100, 6
    s_cbranch_scc1 L_cw_23
L_cwd_24:
    s_mov_b64 exec, 1
    ds_add_u32 v160, v161 offset:28
    s_mov_b64 exec, -1
    s_mov_b32 s33, 4
    s_branch L_p0
L_mid:
    v_and_b32 v11, 31, v1
    v_lshrrev_b32 v12, 5, v1
    v_min_u32 v10, 19, v11
    v_cmp_eq_u32 vcc, 30, v11
    s_nop 1
    v_cndmask_b32 v10, v10, 18, vcc
    v_lshlrev_b32 v10, 4, v10
    v_mul_u32_u24 v13, 320, v12
    v_add_u32 v10, v10, v13
    s_mov_b32 s27, 0
    s_lshl_b32 s29, s36, 12
    v_add_u32 v2, s29, v8
    s_lshl_b32 s29, s36, 9
    v_add_u32 v4, s29, v9
    s_mul_i32 s29, s36, 5120
    v_add_u32 v6, s29, v10
    v_add_u32 v3, 38912, v2
    v_add_u32 v5, 38912, v4
    v_add_u32 v7, 38912, v6
    s_lshl_b32 s33, s25, 1
    s_add_u32 s33, s33, s36
    s_lshr_b32 s29, s37, 1
    s_lshl_b32 s95, s26, 2
    s_add_u32 s95, s95, s29
    s_mul_i32 s29, s33, 36
    s_add_u32 s34, s29, s95
    s_lshl_b32 s34, s34, 10
    s_add_u32 s34, s34, 2621440
    s_lshr_b32 s32, s95, 3
    s_add_u32 s29, s29, s32
    s_add_u32 s29, s29, 32
    s_lshl_b32 s29, s29, 10
    s_and_b32 s32, s95, 4
    s_lshl_b32 s32, s32, 7
    s_add_u32 s29, s29, s32
    s_and_b32 s32, s95, 3
    s_lshl_b32 s32, s32, 2
    s_add_u32 s29, s29, s32
    s_add_u32 s35, s29, 2621440
    s_mov_b32 s23, 0
    v_mul_u32_u24 v11, 7282, v1
    v_lshrrev_b32 v11, 16, v11
    v_mul_u32_u24 v12, 9, v11
    v_sub_u32 v12, v1, v12
    v_mul_u32_u24 v11, 1152, v11
    v_lshl_add_u32 v166, v12, 4, v11
    s_and_b32 s32, s24, 1
    s_lshl_b32 s32, s32, 5
    s_sub_u32 s29, s24, 8
    s_lshl_b32 s29, s29, 4
    s_cmp_lt_u32 s24, 8
    s_cselect_b32 s32, s32, s29
    s_cselect_b32 s29, 31, 15
    v_and_b32 v164, s29, v1
    v_add_u32 v164, s32, v164
    s_sub_u32 s36, s24, 4
    s_lshl_b32 s29, s25, 2
    s_add_u32 s32, s29, s36
    s_mul_i32 s74, s32, 18432
    s_lshl_b32 s29, s36, 7
    s_add_u32 s29, s29, 0
    v_add_u32 v11, s29, v1
    v_mul_u32_u24 v12, 1821, v11
    v_lshrrev_b32 v12, 16, v12
    v_mul_u32_u24 v13, 36, v12
    v_sub_u32 v13, v11, v13
    v_bfe_u32 v14, v13, 2, 2
    v_and_b32 v15, 3, v13
    v_lshrrev_b32 v18, 4, v13
    v_lshlrev_b32 v18, 6, v18
    v_cmp_gt_u32 vcc, 32, v13
    v_lshl_add_u32 v13, v15, 4, v18
    s_nop 0
    v_cndmask_b32 v18, v18, v13, vcc
    v_cndmask_b32 v14, v15, v14, vcc
    v_lshl_add_u32 v12, v12, 2, v14
    v_mul_u32_u24 v12, 1152, v12
    v_add_u32 v18, v18, v12
    s_lshl_b32 s29, s36, 7
    s_add_u32 s29, s29, 64
    v_add_u32 v11, s29, v1
    v_mul_u32_u24 v12, 1821, v11
    v_lshrrev_b32 v12, 16, v12
    v_mul_u32_u24 v13, 36, v12
    v_sub_u32 v13, v11, v13
    v_bfe_u32 v14, v13, 2, 2
    v_and_b32 v15, 3, v13
    v_lshrrev_b32 v19, 4, v13
    v_lshlrev_b32 v19, 6, v19
    v_cmp_gt_u32 vcc, 32, v13
    v_lshl_add_u32 v13, v15, 4, v19
    s_nop 0
    v_cndmask_b32 v19, v19, v13, vcc
    v_cndmask_b32 v14, v15, v14, vcc
    v_lshl_add_u32 v12, v12, 2, v14
    v_mul_u32_u24 v12, 1152, v12
    v_add_u32 v19, v19, v12
    v_add_u32 v11, 512, v1
    v_mul_u32_u24 v12, 1821, v11
    v_lshrrev_b32 v12, 16, v12
    v_mul_u32_u24 v13, 36, v12
    v_sub_u32 v13, v11, v13
    v_bfe_u32 v14, v13, 2, 2
    v_and_b32 v15, 3, v13
    v_lshrrev_b32 v20, 4, v13
    v_lshlrev_b32 v20, 6, v20
    v_cmp_gt_u32 vcc, 32, v13
    v_lshl_add_u32 v13, v15, 4, v20
    s_nop 0
    v_cndmask_b32 v20, v20, v13, vcc
    v_cndmask_b32 v14, v15, v14, vcc
    v_lshl_add_u32 v12, v12, 2, v14
    v_mul_u32_u24 v12, 1152, v12
    v_add_u32 v20, v20, v12
    s_barrier
    s_mov_b32 s94, s92
    s_lshl_b32 s39, s36, 11
    s_mov_b32 s95, 16384
    s_call_b64 s[62:63], L_issue0
    s_call_b64 s[62:63], L_issue0
    s_call_b64 s[62:63], L_issue0
    s_call_b64 s[62:63], L_issue0
    s_cmp_eq_u32 s36, s97
    s_cbranch_scc1 L_qa_26
    s_waitcnt vmcnt(12)
    s_branch L_qb_27
L_qa_26:
    s_waitcnt vmcnt(9)
L_qb_27:
    s_mov_b64 exec, 1
    ds_add_u32 v160, v161 offset:80
    s_mov_b64 exec, -1
    s_call_b64 s[62:63], L_issue0
    s_call_b64 s[62:63], L_issue0
    s_cmp_eq_u32 s36, s97
    s_cbranch_scc1 L_qa_28
    s_waitcnt vmcnt(12)
    s_branch L_qb_29
L_qa_28:
    s_waitcnt vmcnt(9)
L_qb_29:
    s_mov_b64 exec, 1
    ds_add_u32 v160, v161 offset:84
    s_mov_b64 exec, -1
    s_call_b64 s[62:63], L_issue0
    s_mov_b32 s93, 0
    s_branch L_cwe_32
L_cw_30:
    s_sleep 1
L_cwe_32:
    ds_read_b32 v15, v160 offset:4
    s_add_u32 s93, s93, 1
    s_waitcnt lgkmcnt(0)
    v_readfirstlane_b32 s100, v15
    s_cmp_ge_u32 s93, 1280000
    s_cbranch_scc1 L_cwd_31
    s_cmp_lt_u32 s100, 1
    s_cbranch_scc1 L_cw_30
L_cwd_31:
    s_call_b64 s[62:63], L_issue1
    s_cmp_eq_u32 s36, s97
    s_cbranch_scc1 L_qa_33
    s_waitcnt vmcnt(12)
    s_branch L_qb_34
L_qa_33:
    s_waitcnt vmcnt(11)
L_qb_34:
    s_mov_b64 exec, 1
    ds_add_u32 v160, v161 offset:88
    s_mov_b64 exec, -1
    s_call_b64 s[62:63], L_issue1
    s_cmp_eq_u32 s36, s97
    s_cbranch_scc1 L_qa_35
    s_waitcnt vmcnt(8)
    s_branch L_qb_36
L_qa_35:
    s_waitcnt vmcnt(10)
L_qb_36:
    s_mov_b64 exec, 1
    ds_add_u32 v160, v161 offset:92
    s_mov_b64 exec, -1
    s_cmp_eq_u32 s36, s97
    s_cbranch_scc1 L_qa_37
    s_waitcnt vmcnt(4)
    s_branch L_qb_38
L_qa_37:
    s_waitcnt vmcnt(5)
L_qb_38:
    s_mov_b64 exec, 1
    ds_add_u32 v160, v161 offset:96
    s_mov_b64 exec, -1
    s_waitcnt vmcnt(0)
    s_mov_b64 exec, 1
    ds_add_u32 v160, v161 offset:100
    s_mov_b64 exec, -1
    s_mov_b32 s100, s36
    s_mov_b32 s36, 1
    s_mov_b32 s33, s100
    s_branch L_p0help
L_q_t2:
    v_lshrrev_b32 v11, 4, v1
    v_bfe_u32 v13, v1, 2, 2
    v_and_b32 v14, 1, v1
    v_mul_u32_u24 v12, 1152, v11
    v_lshl_add_u32 v12, v13, 4, v12
    v_lshl_add_u32 v22, v14, 3, v12
    v_add_u32 v22, 8704, v22
    s_sub_u32 s29, s24, 10
    s_lshl_b32 s29, s29, 5
    v_and_b32 v12, 15, v1
    v_add_u32 v12, s29, v12
    v_bfe_u32 v13, v12, 1, 3
    v_xor_b32 v13, v13, v11
    v_lshlrev_b32 v15, 7, v12
    v_xor_b32 v14, 0, v13
    v_lshl_add_u32 v24, v14, 4, v15
    v_xor_b32 v14, 4, v13
    v_lshl_add_u32 v25, v14, 4, v15
    v_mul_u32_u24 v26, 152, v12
    v_lshl_add_u32 v26, v11, 3, v26
    v_add_u32 v26, 41088, v26
    v_mov_b32 v72, 0
    v_mov_b32 v73, 0
    v_mov_b32 v74, 0
    v_mov_b32 v75, 0
    v_mov_b32 v76, 0
    v_mov_b32 v77, 0
    v_mov_b32 v78, 0
    v_mov_b32 v79, 0
    s_mov_b32 s93, 0
    s_branch L_cwe_41
L_cw_39:
    s_sleep 1
L_cwe_41:
    ds_read_b32 v15, v160 offset:4
    s_add_u32 s93, s93, 1
    s_waitcnt lgkmcnt(0)
    v_readfirstlane_b32 s100, v15
    s_cmp_ge_u32 s93, 1280000
    s_cbranch_scc1 L_cwd_40
    s_cmp_lt_u32 s100, 1
    s_cbranch_scc1 L_cw_39
L_cwd_40:
    s_mov_b32 s93, 0
    s_branch L_cwe_44
L_cw_42:
    s_sleep 1
L_cwe_44:
    ds_read_b32 v15, v160 offset:80
    s_add_u32 s93, s93, 1
    s_waitcnt lgkmcnt(0)
    v_readfirstlane_b32 s100, v15
    s_cmp_ge_u32 s93, 1280000
    s_cbranch_scc1 L_cwd_43
    s_cmp_lt_u32 s100, 4
    s_cbranch_scc1 L_cw_42
L_cwd_43:
    ds_read_b64_tr_b16 v[104:105], v22 offset:0
    ds_read_b64_tr_b16 v[106:107], v22 offset:576
    ds_read_b128 v[108:111], v24 offset:0
    ds_read_b128 v[112:115], v24 offset:2048
    ds_read_b64_tr_b16 v[116:117], v22 offset:4608
    ds_read_b64_tr_b16 v[118:119], v22 offset:5184
    ds_read_b128 v[120:123], v25 offset:0
    ds_read_b128 v[124:127], v25 offset:2048
    s_waitcnt lgkmcnt(4)
    v_mfma_f32_16x16x32_bf16 v[72:75], v[104:107], v[108:111], v[72:75]
    v_mfma_f32_16x16x32_bf16 v[76:79], v[104:107], v[112:115], v[76:79]
    s_waitcnt lgkmcnt(0)
    v_mfma_f32_16x16x32_bf16 v[72:75], v[116:119], v[120:123], v[72:75]
    v_mfma_f32_16x16x32_bf16 v[76:79], v[116:119], v[124:127], v[76:79]
    v_add_u32 v22, 17408, v22
    v_add_u32 v24, 17408, v24
    v_add_u32 v25, 17408, v25
    s_mov_b32 s93, 0
    s_branch L_cwe_47
L_cw_45:
    s_sleep 1
L_cwe_47:
    ds_read_b32 v15, v160 offset:84
    s_add_u32 s93, s93, 1
    s_waitcnt lgkmcnt(0)
    v_readfirstlane_b32 s100, v15
    s_cmp_ge_u32 s93, 1280000
    s_cbranch_scc1 L_cwd_46
    s_cmp_lt_u32 s100, 4
    s_cbranch_scc1 L_cw_45
L_cwd_46:
    ds_read_b64_tr_b16 v[104:105], v22 offset:0
    ds_read_b64_tr_b16 v[106:107], v22 offset:576
    ds_read_b128 v[108:111], v24 offset:0
    ds_read_b128 v[112:115], v24 offset:2048
    ds_read_b64_tr_b16 v[116:117], v22 offset:4608
    ds_read_b64_tr_b16 v[118:119], v22 offset:5184
    ds_read_b128 v[120:123], v25 offset:0
    ds_read_b128 v[124:127], v25 offset:2048
    ds_read_b64_tr_b16 v[128:129], v22 offset:17408
    ds_read_b64_tr_b16 v[130:131], v22 offset:17984
    ds_read_b128 v[132:135], v24 offset:17408
    ds_read_b128 v[136:139], v24 offset:19456
    s_waitcnt lgkmcnt(8)
    v_mfma_f32_16x16x32_bf16 v[72:75], v[104:107], v[108:111], v[72:75]
    v_mfma_f32_16x16x32_bf16 v[76:79], v[104:107], v[112:115], v[76:79]
    ds_read_b64_tr_b16 v[104:105], v22 offset:22016
    ds_read_b64_tr_b16 v[106:107], v22 offset:22592
    ds_read_b128 v[108:111], v25 offset:17408
    ds_read_b128 v[112:115], v25 offset:19456
    s_waitcnt lgkmcnt(8)
    v_mfma_f32_16x16x32_bf16 v[72:75], v[116:119], v[120:123], v[72:75]
    v_mfma_f32_16x16x32_bf16 v[76:79], v[116:119], v[124:127], v[76:79]
    s_waitcnt lgkmcnt(4)
    v_mfma_f32_16x16x32_bf16 v[72:75], v[128:131], v[132:135], v[72:75]
    v_mfma_f32_16x16x32_bf16 v[76:79], v[128:131], v[136:139], v[76:79]
    s_waitcnt lgkmcnt(0)
    v_mfma_f32_16x16x32_bf16 v[72:75], v[104:107], v[108:111], v[72:75]
    v_mfma_f32_16x16x32_bf16 v[76:79], v[104:107], v[112:115], v[76:79]
    s_mov_b64 exec, 1
    ds_add_u32 v160, v161 offset:20
    s_mov_b64 exec, -1
    v_add_u32 v22, 34816, v22
    v_add_u32 v24, 34816, v24
    v_add_u32 v25, 34816, v25
    s_mov_b32 s93, 0
    s_branch L_cwe_50
L_cw_48:
    s_sleep 1
L_cwe_50:
    ds_read_b32 v15, v160 offset:88
    s_add_u32 s93, s93, 1
    s_waitcnt lgkmcnt(0)
    v_readfirstlane_b32 s100, v15
    s_cmp_ge_u32 s93, 1280000
    s_cbranch_scc1 L_cwd_49
    s_cmp_lt_u32 s100, 4
    s_cbranch_scc1 L_cw_48
L_cwd_49:
    ds_read_b64_tr_b16 v[104:105], v22 offset:0
    ds_read_b64_tr_b16 v[106:107], v22 offset:576
    ds_read_b128 v[108:111], v24 offset:0
    ds_read_b128 v[112:115], v24 offset:2048
    ds_read_b64_tr_b16 v[116:117], v22 offset:4608
    ds_read_b64_tr_b16 v[118:119], v22 offset:5184
    ds_read_b128 v[120:123], v25 offset:0
    ds_read_b128 v[124:127], v25 offset:2048
    ds_read_b64_tr_b16 v[128:129], v22 offset:17408
    ds_read_b64_tr_b16 v[130:131], v22 offset:17984
    ds_read_b128 v[132:135], v24 offset:17408
    ds_read_b128 v[136:139], v24 offset:19456
    s_waitcnt lgkmcnt(8)
    v_mfma_f32_16x16x32_bf16 v[72:75], v[104:107], v[108:111], v[72:75]
    v_mfma_f32_16x16x32_bf16 v[76:79], v[104:107], v[112:115], v[76:79]
    ds_read_b64_tr_b16 v[104:105], v22 offset:22016
    ds_read_b64_tr_b16 v[106:107], v22 offset:22592
    ds_read_b128 v[108:111], v25 offset:17408
    ds_read_b128 v[112:115], v25 offset:19456
    s_waitcnt lgkmcnt(8)
    v_mfma_f32_16x16x32_bf16 v[72:75], v[116:119], v[120:123], v[72:75]
    v_mfma_f32_16x16x32_bf16 v[76:79], v[116:119], v[124:127], v[76:79]
    s_waitcnt lgkmcnt(4)
    v_mfma_f32_16x16x32_bf16 v[72:75], v[128:131], v[132:135], v[72:75]
    v_mfma_f32_16x16x32_bf16 v[76:79], v[128:131], v[136:139], v[76:79]
    s_waitcnt lgkmcnt(0)
    v_mfma_f32_16x16x32_bf16 v[72:75], v[104:107], v[108:111], v[72:75]
    v_mfma_f32_16x16x32_bf16 v[76:79], v[104:107], v[112:115], v[76:79]
    v_add_u32 v22, 34816, v22
    v_add_u32 v24, 34816, v24
    v_add_u32 v25, 34816, v25
    s_mov_b32 s93, 0
    s_branch L_cwe_53
L_cw_51:
    s_sleep 1
L_cwe_53:
    ds_read_b32 v15, v160 offset:92
    s_add_u32 s93, s93, 1
    s_waitcnt lgkmcnt(0)
    v_readfirstlane_b32 s100, v15
    s_cmp_ge_u32 s93, 1280000
    s_cbranch_scc1 L_cwd_52
    s_cmp_lt_u32 s100, 4
    s_cbranch_scc1 L_cw_51
L_cwd_52:
    ds_read_b64_tr_b16 v[104:105], v22 offset:0
    ds_read_b64_tr_b16 v[106:107], v22 offset:576
    ds_read_b128 v[108:111], v24 offset:0
    ds_read_b128 v[112:115], v24 offset:2048
    ds_read_b64_tr_b16 v[116:117], v22 offset:4608
    ds_read_b64_tr_b16 v[118:119], v22 offset:5184
    ds_read_b128 v[120:123], v25 offset:0
    ds_read_b128 v[124:127], v25 offset:2048
    ds_read_b64_tr_b16 v[128:129], v22 offset:17408
    ds_read_b64_tr_b16 v[130:131], v22 offset:17984
    ds_read_b128 v[132:135], v24 offset:17408
    ds_read_b128 v[136:139], v24 offset:19456
    s_waitcnt lgkmcnt(8)
    v_mfma_f32_16x16x32_bf16 v[72:75], v[104:107], v[108:111], v[72:75]
    v_mfma_f32_16x16x32_bf16 v[76:79], v[104:107], v[112:115], v[76:79]
    ds_read_b64_tr_b16 v[104:105], v22 offset:22016
    ds_read_b64_tr_b16 v[106:107], v22 offset:22592
    ds_read_b128 v[108:111], v25 offset:17408
    ds_read_b128 v[112:115], v25 offset:19456
    s_waitcnt lgkmcnt(8)
    v_mfma_f32_16x16x32_bf16 v[72:75], v[116:119], v[120:123], v[72:75]
    v_mfma_f32_16x16x32_bf16 v[76:79], v[116:119], v[124:127], v[76:79]
    s_waitcnt lgkmcnt(4)
    v_mfma_f32_16x16x32_bf16 v[72:75], v[128:131], v[132:135], v[72:75]
    v_mfma_f32_16x16x32_bf16 v[76:79], v[128:131], v[136:139], v[76:79]
    s_waitcnt lgkmcnt(0)
    v_mfma_f32_16x16x32_bf16 v[72:75], v[104:107], v[108:111], v[72:75]
    v_mfma_f32_16x16x32_bf16 v[76:79], v[104:107], v[112:115], v[76:79]
    v_add_u32 v22, 34816, v22
    v_add_u32 v24, 34816, v24
    v_add_u32 v25, 34816, v25
    s_mov_b32 s93, 0
    s_branch L_cwe_56
L_cw_54:
    s_sleep 1
L_cwe_56:
    ds_read_b32 v15, v160 offset:96
    s_add_u32 s93, s93, 1
    s_waitcnt lgkmcnt(0)
    v_readfirstlane_b32 s100, v15
    s_cmp_ge_u32 s93, 1280000
    s_cbranch_scc1 L_cwd_55
    s_cmp_lt_u32 s100, 4
    s_cbranch_scc1 L_cw_54
L_cwd_55:
    ds_read_b64_tr_b16 v[104:105], v22 offset:0
    ds_read_b64_tr_b16 v[106:107], v22 offset:576
    ds_read_b128 v[108:111], v24 offset:0
    ds_read_b128 v[112:115], v24 offset:2048
    ds_read_b64_tr_b16 v[116:117], v22 offset:4608
    ds_read_b64_tr_b16 v[118:119], v22 offset:5184
    ds_read_b128 v[120:123], v25 offset:0
    ds_read_b128 v[124:127], v25 offset:2048
    s_waitcnt lgkmcnt(4)
    v_mfma_f32_16x16x32_bf16 v[72:75], v[104:107], v[108:111], v[72:75]
    v_mfma_f32_16x16x32_bf16 v[76:79], v[104:107], v[112:115], v[76:79]
    s_waitcnt lgkmcnt(0)
    v_mfma_f32_16x16x32_bf16 v[72:75], v[116:119], v[120:123], v[72:75]
    v_mfma_f32_16x16x32_bf16 v[76:79], v[116:119], v[124:127], v[76:79]
    v_add_u32 v22, 17408, v22
    v_add_u32 v24, 17408, v24
    v_add_u32 v25, 17408, v25
    s_mov_b32 s93, 0
    s_branch L_cwe_59
L_cw_57:
    s_sleep 1
L_cwe_59:
    ds_read_b32 v15, v160 offset:20
    s_add_u32 s93, s93, 1
    s_waitcnt lgkmcnt(0)
    v_readfirstlane_b32 s100, v15
    s_cmp_ge_u32 s93, 1280000
    s_cbranch_scc1 L_cwd_58
    s_cmp_lt_u32 s100, 6
    s_cbranch_scc1 L_cw_57
L_cwd_58:
    s_mov_b32 s93, 0
    s_branch L_cwe_62
L_cw_60:
    s_sleep 1
L_cwe_62:
    ds_read_b32 v15, v160 offset:100
    s_add_u32 s93, s93, 1
    s_waitcnt lgkmcnt(0)
    v_readfirstlane_b32 s100, v15
    s_cmp_ge_u32 s93, 1280000
    s_cbranch_scc1 L_cwd_61
    s_cmp_lt_u32 s100, 4
    s_cbranch_scc1 L_cw_60
L_cwd_61:
    ds_read_b64_tr_b16 v[104:105], v22 offset:0
    ds_read_b64_tr_b16 v[106:107], v22 offset:576
    ds_read_b128 v[108:111], v24 offset:0
    ds_read_b128 v[112:115], v24 offset:2048
    ds_read_b64_tr_b16 v[116:117], v22 offset:4608
    ds_read_b64_tr_b16 v[118:119], v22 offset:5184
    ds_read_b128 v[120:123], v25 offset:0
    ds_read_b128 v[124:127], v25 offset:2048
    s_waitcnt lgkmcnt(4)
    v_mfma_f32_16x16x32_bf16 v[72:75], v[104:107], v[108:111], v[72:75]
    v_mfma_f32_16x16x32_bf16 v[76:79], v[104:107], v[112:115], v[76:79]
    s_waitcnt lgkmcnt(0)
    v_mfma_f32_16x16x32_bf16 v[72:75], v[116:119], v[120:123], v[72:75]
    v_mfma_f32_16x16x32_bf16 v[76:79], v[116:119], v[124:127], v[76:79]
    s_mov_b32 s29, 1051597459
    s_nop 6
    v_mul_f32 v72, s29, v72
    v_mul_f32 v73, s29, v73
    v_mul_f32 v74, s29, v74
    v_mul_f32 v75, s29, v75
    v_mul_f32 v76, s29, v76
    v_mul_f32 v77, s29, v77
    v_mul_f32 v78, s29, v78
    v_mul_f32 v79, s29, v79
    v_cvt_pk_bf16_f32 v32, v72, v73
    v_cvt_pk_bf16_f32 v33, v74, v75
    v_cvt_pk_bf16_f32 v34, v76, v77
    v_cvt_pk_bf16_f32 v35, v78, v79
    s_mov_b32 exec_hi, 0
    ds_write_b64 v26, v[32:33]
    ds_write_b64 v26, v[34:35] offset:2432
    s_mov_b32 exec_hi, -1
    s_waitcnt lgkmcnt(0)
    s_branch L_q_add
L_lo:
    s_barrier
    v_and_b32 v11, 31, v1
    v_lshrrev_b32 v12, 5, v1
    v_min_u32 v10, 19, v11
    v_cmp_eq_u32 vcc, 30, v11
    s_nop 1
    v_cndmask_b32 v10, v10, 18, vcc
    v_lshlrev_b32 v10, 4, v10
    v_mul_u32_u24 v13, 320, v12
    v_add_u32 v10, v10, v13
    s_mov_b32 s27, 0
    s_lshl_b32 s29, s36, 12
    v_add_u32 v2, s29, v8
    s_lshl_b32 s29, s36, 9
    v_add_u32 v4, s29, v9
    s_mul_i32 s29, s36, 5120
    v_add_u32 v6, s29, v10
    v_add_u32 v3, 38912, v2
    v_add_u32 v5, 38912, v4
    v_add_u32 v7, 38912, v6
    s_lshl_b32 s33, s25, 1
    s_add_u32 s33, s33, s36
    s_lshr_b32 s29, s37, 1
    s_lshl_b32 s95, s26, 2
    s_add_u32 s95, s95, s29
    s_mul_i32 s29, s33, 36
    s_add_u32 s34, s29, s95
    s_lshl_b32 s34, s34, 10
    s_add_u32 s34, s34, 2621440
    s_lshr_b32 s32, s95, 3
    s_add_u32 s29, s29, s32
    s_add_u32 s29, s29, 32
    s_lshl_b32 s29, s29, 10
    s_and_b32 s32, s95, 4
    s_lshl_b32 s32, s32, 7
    s_add_u32 s29, s29, s32
    s_and_b32 s32, s95, 3
    s_lshl_b32 s32, s32, 2
    s_add_u32 s29, s29, s32
    s_add_u32 s35, s29, 2621440
    s_mov_b32 s23, 0
    v_mul_u32_u24 v11, 7282, v1
    v_lshrrev_b32 v11, 16, v11
    v_mul_u32_u24 v12, 9, v11
    v_sub_u32 v12, v1, v12
    v_mul_u32_u24 v11, 1152, v11
    v_lshl_add_u32 v166, v12, 4, v11
    s_and_b32 s32, s24, 1
    s_lshl_b32 s32, s32, 5
    s_sub_u32 s29, s24, 8
    s_lshl_b32 s29, s29, 4
    s_cmp_lt_u32 s24, 8
    s_cselect_b32 s32, s32, s29
    s_cselect_b32 s29, 31, 15
    v_and_b32 v164, s29, v1
    v_add_u32 v164, s32, v164
    v_lshrrev_b32 v11, 5, v1
    v_bfe_u32 v12, v1, 4, 1
    v_bfe_u32 v13, v1, 2, 2
    v_and_b32 v14, 3, v1
    v_lshl_add_u32 v15, v12, 2, v14
    v_mul_u32_u24 v12, 1152, v11
    v_lshl_add_u32 v12, v13, 6, v12
    v_lshl_add_u32 v22, v15, 3, v12
    s_lshr_b32 s29, s24, 1
    s_lshl_b32 s29, s29, 8
    s_add_u32 s29, s29, 8192
    v_add_u32 v22, s29, v22
    s_and_b32 s32, s24, 1
    s_lshl_b32 s29, s32, 5
    v_and_b32 v12, 31, v1
    v_add_u32 v12, s29, v12
    v_bfe_u32 v13, v12, 1, 3
    v_xor_b32 v13, v13, v11
    v_lshlrev_b32 v12, 7, v12
    v_xor_b32 v14, 0, v13
    v_lshl_add_u32 v24, v14, 4, v12
    v_xor_b32 v14, 2, v13
    v_lshl_add_u32 v25, v14, 4, v12
    v_xor_b32 v14, 4, v13
    v_lshl_add_u32 v26, v14, 4, v12
    v_xor_b32 v14, 6, v13
    v_lshl_add_u32 v27, v14, 4, v12
    v_mov_b32 v72, 0
    v_mov_b32 v73, 0
    v_mov_b32 v74, 0
    v_mov_b32 v75, 0
    v_mov_b32 v76, 0
    v_mov_b32 v77, 0
    v_mov_b32 v78, 0
    v_mov_b32 v79, 0
    v_mov_b32 v80, 0
    v_mov_b32 v81, 0
    v_mov_b32 v82, 0
    v_mov_b32 v83, 0
    v_mov_b32 v84, 0
    v_mov_b32 v85, 0
    v_mov_b32 v86, 0
    v_mov_b32 v87, 0
    s_waitcnt vmcnt(0)
    s_mov_b32 s93, 0
    s_branch L_cwe_65
L_cw_63:
    s_sleep 2
L_cwe_65:
    ds_read_b32 v15, v160 offset:4
    s_add_u32 s93, s93, 1
    s_waitcnt lgkmcnt(0)
    v_readfirstlane_b32 s100, v15
    s_cmp_ge_u32 s93, 1280000
    s_cbranch_scc1 L_cwd_64
    s_cmp_lt_u32 s100, 1
    s_cbranch_scc1 L_cw_63
L_cwd_64:
    s_mov_b32 s93, 0
    s_branch L_cwe_68
L_cw_66:
    s_sleep 1
L_cwe_68:
    ds_read_b32 v15, v160 offset:80
    s_add_u32 s93, s93, 1
    s_waitcnt lgkmcnt(0)
    v_readfirstlane_b32 s100, v15
    s_cmp_ge_u32 s93, 1280000
    s_cbranch_scc1 L_cwd_67
    s_cmp_lt_u32 s100, 4
    s_cbranch_scc1 L_cw_66
L_cwd_67:
    ds_read_b64_tr_b16 v[40:41], v22 offset:0
    ds_read_b64_tr_b16 v[42:43], v22 offset:576
    ds_read_b128 v[44:47], v24 offset:0
    ds_read_b64_tr_b16 v[48:49], v22 offset:2304
    ds_read_b64_tr_b16 v[50:51], v22 offset:2880
    ds_read_b128 v[52:55], v25 offset:0
    ds_read_b64_tr_b16 v[56:57], v22 offset:4608
    ds_read_b64_tr_b16 v[58:59], v22 offset:5184
    ds_read_b128 v[60:63], v26 offset:0
    ds_read_b64_tr_b16 v[64:65], v22 offset:6912
    ds_read_b64_tr_b16 v[66:67], v22 offset:7488
    ds_read_b128 v[68:71], v27 offset:0
    s_waitcnt lgkmcnt(9)
    v_mfma_f32_32x32x16_bf16 v[72:87], v[40:43], v[44:47], v[72:87]
    s_waitcnt lgkmcnt(6)
    v_mfma_f32_32x32x16_bf16 v[72:87], v[48:51], v[52:55], v[72:87]
    s_waitcnt lgkmcnt(3)
    v_mfma_f32_32x32x16_bf16 v[72:87], v[56:59], v[60:63], v[72:87]
    s_waitcnt lgkmcnt(0)
    v_mfma_f32_32x32x16_bf16 v[72:87], v[64:67], v[68:71], v[72:87]
    v_add_u32 v22, 17408, v22
    v_add_u32 v24, 17408, v24
    v_add_u32 v25, 17408, v25
    v_add_u32 v26, 17408, v26
    v_add_u32 v27, 17408, v27
    s_mov_b32 s93, 0
    s_branch L_cwe_71
L_cw_69:
    s_sleep 1
L_cwe_71:
    ds_read_b32 v15, v160 offset:84
    s_add_u32 s93, s93, 1
    s_waitcnt lgkmcnt(0)
    v_readfirstlane_b32 s100, v15
    s_cmp_ge_u32 s93, 1280000
    s_cbranch_scc1 L_cwd_70
    s_cmp_lt_u32 s100, 4
    s_cbranch_scc1 L_cw_69
L_cwd_70:
    ds_read_b64_tr_b16 v[40:41], v22 offset:0
    ds_read_b64_tr_b16 v[42:43], v22 offset:576
    ds_read_b128 v[44:47], v24 offset:0
    ds_read_b64_tr_b16 v[48:49], v22 offset:2304
    ds_read_b64_tr_b16 v[50:51], v22 offset:2880
    ds_read_b128 v[52:55], v25 offset:0
    ds_read_b64_tr_b16 v[56:57], v22 offset:4608
    ds_read_b64_tr_b16 v[58:59], v22 offset:5184
    ds_read_b128 v[60:63], v26 offset:0
    ds_read_b64_tr_b16 v[64:65], v22 offset:6912
    ds_read_b64_tr_b16 v[66:67], v22 offset:7488
    ds_read_b128 v[68:71], v27 offset:0
    s_waitcnt lgkmcnt(9)
    v_mfma_f32_32x32x16_bf16 v[72:87], v[40:43], v[44:47], v[72:87]
    ds_read_b64_tr_b16 v[40:41], v22 offset:17408
    ds_read_b64_tr_b16 v[42:43], v22 offset:17984
    ds_read_b128 v[44:47], v24 offset:17408
    s_waitcnt lgkmcnt(9)
    v_mfma_f32_32x32x16_bf16 v[72:87], v[48:51], v[52:55], v[72:87]
    ds_read_b64_tr_b16 v[48:49], v22 offset:19712
    ds_read_b64_tr_b16 v[50:51], v22 offset:20288
    ds_read_b128 v[52:55], v25 offset:17408
    s_waitcnt lgkmcnt(9)
    v_mfma_f32_32x32x16_bf16 v[72:87], v[56:59], v[60:63], v[72:87]
    ds_read_b64_tr_b16 v[56:57], v22 offset:22016
    ds_read_b64_tr_b16 v[58:59], v22 offset:22592
    ds_read_b128 v[60:63], v26 offset:17408
    s_waitcnt lgkmcnt(9)
    v_mfma_f32_32x32x16_bf16 v[72:87], v[64:67], v[68:71], v[72:87]
    ds_read_b64_tr_b16 v[64:65], v22 offset:24320
    ds_read_b64_tr_b16 v[66:67], v22 offset:24896
    ds_read_b128 v[68:71], v27 offset:17408
    s_waitcnt lgkmcnt(9)
    v_mfma_f32_32x32x16_bf16 v[72:87], v[40:43], v[44:47], v[72:87]
    s_waitcnt lgkmcnt(6)
    v_mfma_f32_32x32x16_bf16 v[72:87], v[48:51], v[52:55], v[72:87]
    s_waitcnt lgkmcnt(3)
    v_mfma_f32_32x32x16_bf16 v[72:87], v[56:59], v[60:63], v[72:87]
    s_waitcnt lgkmcnt(0)
    v_mfma_f32_32x32x16_bf16 v[72:87], v[64:67], v[68:71], v[72:87]
    s_mov_b64 exec, 1
    ds_add_u32 v160, v161 offset:20
    s_mov_b64 exec, -1
    v_add_u32 v22, 34816, v22
    v_add_u32 v24, 34816, v24
    v_add_u32 v25, 34816, v25
    v_add_u32 v26, 34816, v26
    v_add_u32 v27, 34816, v27
    s_mov_b32 s93, 0
    s_branch L_cwe_74
L_cw_72:
    s_sleep 1
L_cwe_74:
    ds_read_b32 v15, v160 offset:88
    s_add_u32 s93, s93, 1
    s_waitcnt lgkmcnt(0)
    v_readfirstlane_b32 s100, v15
    s_cmp_ge_u32 s93, 1280000
    s_cbranch_scc1 L_cwd_73
    s_cmp_lt_u32 s100, 4
    s_cbranch_scc1 L_cw_72
L_cwd_73:
    ds_read_b64_tr_b16 v[40:41], v22 offset:0
    ds_read_b64_tr_b16 v[42:43], v22 offset:576
    ds_read_b128 v[44:47], v24 offset:0
    ds_read_b64_tr_b16 v[48:49], v22 offset:2304
    ds_read_b64_tr_b16 v[50:51], v22 offset:2880
    ds_read_b128 v[52:55], v25 offset:0
    ds_read_b64_tr_b16 v[56:57], v22 offset:4608
    ds_read_b64_tr_b16 v[58:59], v22 offset:5184
    ds_read_b128 v[60:63], v26 offset:0
    ds_read_b64_tr_b16 v[64:65], v22 offset:6912
    ds_read_b64_tr_b16 v[66:67], v22 offset:7488
    ds_read_b128 v[68:71], v27 offset:0
    s_waitcnt lgkmcnt(9)
    v_mfma_f32_32x32x16_bf16 v[72:87], v[40:43], v[44:47], v[72:87]
    ds_read_b64_tr_b16 v[40:41], v22 offset:17408
    ds_read_b64_tr_b16 v[42:43], v22 offset:17984
    ds_read_b128 v[44:47], v24 offset:17408
    s_waitcnt lgkmcnt(9)
    v_mfma_f32_32x32x16_bf16 v[72:87], v[48:51], v[52:55], v[72:87]
    ds_read_b64_tr_b16 v[48:49], v22 offset:19712
    ds_read_b64_tr_b16 v[50:51], v22 offset:20288
    ds_read_b128 v[52:55], v25 offset:17408
    s_waitcnt lgkmcnt(9)
    v_mfma_f32_32x32x16_bf16 v[72:87], v[56:59], v[60:63], v[72:87]
    ds_read_b64_tr_b16 v[56:57], v22 offset:22016
    ds_read_b64_tr_b16 v[58:59], v22 offset:22592
    ds_read_b128 v[60:63], v26 offset:17408
    s_waitcnt lgkmcnt(9)
    v_mfma_f32_32x32x16_bf16 v[72:87], v[64:67], v[68:71], v[72:87]
    ds_read_b64_tr_b16 v[64:65], v22 offset:24320
    ds_read_b64_tr_b16 v[66:67], v22 offset:24896
    ds_read_b128 v[68:71], v27 offset:17408
    s_waitcnt lgkmcnt(9)
    v_mfma_f32_32x32x16_bf16 v[72:87], v[40:43], v[44:47], v[72:87]
    s_waitcnt lgkmcnt(6)
    v_mfma_f32_32x32x16_bf16 v[72:87], v[48:51], v[52:55], v[72:87]
    s_waitcnt lgkmcnt(3)
    v_mfma_f32_32x32x16_bf16 v[72:87], v[56:59], v[60:63], v[72:87]
    s_waitcnt lgkmcnt(0)
    v_mfma_f32_32x32x16_bf16 v[72:87], v[64:67], v[68:71], v[72:87]
    v_add_u32 v22, 34816, v22
    v_add_u32 v24, 34816, v24
    v_add_u32 v25, 34816, v25
    v_add_u32 v26, 34816, v26
    v_add_u32 v27, 34816, v27
    s_mov_b32 s93, 0
    s_branch L_cwe_77
L_cw_75:
    s_sleep 1
L_cwe_77:
    ds_read_b32 v15, v160 offset:92
    s_add_u32 s93, s93, 1
    s_waitcnt lgkmcnt(0)
    v_readfirstlane_b32 s100, v15
    s_cmp_ge_u32 s93, 1280000
    s_cbranch_scc1 L_cwd_76
    s_cmp_lt_u32 s100, 4
    s_cbranch_scc1 L_cw_75
L_cwd_76:
    ds_read_b64_tr_b16 v[40:41], v22 offset:0
    ds_read_b64_tr_b16 v[42:43], v22 offset:576
    ds_read_b128 v[44:47], v24 offset:0
    ds_read_b64_tr_b16 v[48:49], v22 offset:2304
    ds_read_b64_tr_b16 v[50:51], v22 offset:2880
    ds_read_b128 v[52:55], v25 offset:0
    ds_read_b64_tr_b16 v[56:57], v22 offset:4608
    ds_read_b64_tr_b16 v[58:59], v22 offset:5184
    ds_read_b128 v[60:63], v26 offset:0
    ds_read_b64_tr_b16 v[64:65], v22 offset:6912
    ds_read_b64_tr_b16 v[66:67], v22 offset:7488
    ds_read_b128 v[68:71], v27 offset:0
    s_waitcnt lgkmcnt(9)
    v_mfma_f32_32x32x16_bf16 v[72:87], v[40:43], v[44:47], v[72:87]
    ds_read_b64_tr_b16 v[40:41], v22 offset:17408
    ds_read_b64_tr_b16 v[42:43], v22 offset:17984
    ds_read_b128 v[44:47], v24 offset:17408
    s_waitcnt lgkmcnt(9)
    v_mfma_f32_32x32x16_bf16 v[72:87], v[48:51], v[52:55], v[72:87]
    ds_read_b64_tr_b16 v[48:49], v22 offset:19712
    ds_read_b64_tr_b16 v[50:51], v22 offset:20288
    ds_read_b128 v[52:55], v25 offset:17408
    s_waitcnt lgkmcnt(9)
    v_mfma_f32_32x32x16_bf16 v[72:87], v[56:59], v[60:63], v[72:87]
    ds_read_b64_tr_b16 v[56:57], v22 offset:22016
    ds_read_b64_tr_b16 v[58:59], v22 offset:22592
    ds_read_b128 v[60:63], v26 offset:17408
    s_waitcnt lgkmcnt(9)
    v_mfma_f32_32x32x16_bf16 v[72:87], v[64:67], v[68:71], v[72:87]
    ds_read_b64_tr_b16 v[64:65], v22 offset:24320
    ds_read_b64_tr_b16 v[66:67], v22 offset:24896
    ds_read_b128 v[68:71], v27 offset:17408
    s_waitcnt lgkmcnt(9)
    v_mfma_f32_32x32x16_bf16 v[72:87], v[40:43], v[44:47], v[72:87]
    s_waitcnt lgkmcnt(6)
    v_mfma_f32_32x32x16_bf16 v[72:87], v[48:51], v[52:55], v[72:87]
    s_waitcnt lgkmcnt(3)
    v_mfma_f32_32x32x16_bf16 v[72:87], v[56:59], v[60:63], v[72:87]
    s_waitcnt lgkmcnt(0)
    v_mfma_f32_32x32x16_bf16 v[72:87], v[64:67], v[68:71], v[72:87]
    v_add_u32 v22, 34816, v22
    v_add_u32 v24, 34816, v24
    v_add_u32 v25, 34816, v25
    v_add_u32 v26, 34816, v26
    v_add_u32 v27, 34816, v27
    s_mov_b32 s93, 0
    s_branch L_cwe_80
L_cw_78:
    s_sleep 1
L_cwe_80:
    ds_read_b32 v15, v160 offset:96
    s_add_u32 s93, s93, 1
    s_waitcnt lgkmcnt(0)
    v_readfirstlane_b32 s100, v15
    s_cmp_ge_u32 s93, 1280000
    s_cbranch_scc1 L_cwd_79
    s_cmp_lt_u32 s100, 4
    s_cbranch_scc1 L_cw_78
L_cwd_79:
    ds_read_b64_tr_b16 v[40:41], v22 offset:0
    ds_read_b64_tr_b16 v[42:43], v22 offset:576
    ds_read_b128 v[44:47], v24 offset:0
    ds_read_b64_tr_b16 v[48:49], v22 offset:2304
    ds_read_b64_tr_b16 v[50:51], v22 offset:2880
    ds_read_b128 v[52:55], v25 offset:0
    ds_read_b64_tr_b16 v[56:57], v22 offset:4608
    ds_read_b64_tr_b16 v[58:59], v22 offset:5184
    ds_read_b128 v[60:63], v26 offset:0
    ds_read_b64_tr_b16 v[64:65], v22 offset:6912
    ds_read_b64_tr_b16 v[66:67], v22 offset:7488
    ds_read_b128 v[68:71], v27 offset:0
    s_waitcnt lgkmcnt(9)
    v_mfma_f32_32x32x16_bf16 v[72:87], v[40:43], v[44:47], v[72:87]
    s_waitcnt lgkmcnt(6)
    v_mfma_f32_32x32x16_bf16 v[72:87], v[48:51], v[52:55], v[72:87]
    s_waitcnt lgkmcnt(3)
    v_mfma_f32_32x32x16_bf16 v[72:87], v[56:59], v[60:63], v[72:87]
    s_waitcnt lgkmcnt(0)
    v_mfma_f32_32x32x16_bf16 v[72:87], v[64:67], v[68:71], v[72:87]
    v_add_u32 v22, 17408, v22
    v_add_u32 v24, 17408, v24
    v_add_u32 v25, 17408, v25
    v_add_u32 v26, 17408, v26
    v_add_u32 v27, 17408, v27
    s_mov_b32 s93, 0
    s_branch L_cwe_83
L_cw_81:
    s_sleep 1
L_cwe_83:
    ds_read_b32 v15, v160 offset:20
    s_add_u32 s93, s93, 1
    s_waitcnt lgkmcnt(0)
    v_readfirstlane_b32 s100, v15
    s_cmp_ge_u32 s93, 1280000
    s_cbranch_scc1 L_cwd_82
    s_cmp_lt_u32 s100, 6
    s_cbranch_scc1 L_cw_81
L_cwd_82:
    s_and_b32 s29, s24, 1
    s_lshl_b32 s29, s29, 5
    v_and_b32 v12, 31, v1
    v_add_u32 v12, s29, v12
    v_mul_u32_u24 v12, 152, v12
    v_lshrrev_b32 v11, 5, v1
    v_lshl_add_u32 v12, v11, 3, v12
    s_lshr_b32 s29, s24, 1
    s_lshl_b32 s29, s29, 6
    s_add_u32 s29, s29, 40960
    v_add_u32 v12, s29, v12
    s_mov_b32 s93, 0
    s_branch L_cwe_86
L_cw_84:
    s_sleep 1
L_cwe_86:
    ds_read_b32 v15, v160 offset:100
    s_add_u32 s93, s93, 1
    s_waitcnt lgkmcnt(0)
    v_readfirstlane_b32 s100, v15
    s_cmp_ge_u32 s93, 1280000
    s_cbranch_scc1 L_cwd_85
    s_cmp_lt_u32 s100, 4
    s_cbranch_scc1 L_cw_84
L_cwd_85:
    ds_read_b64_tr_b16 v[40:41], v22 offset:0
    ds_read_b64_tr_b16 v[42:43], v22 offset:576
    ds_read_b128 v[44:47], v24 offset:0
    ds_read_b64_tr_b16 v[48:49], v22 offset:2304
    ds_read_b64_tr_b16 v[50:51], v22 offset:2880
    ds_read_b128 v[52:55], v25 offset:0
    ds_read_b64_tr_b16 v[56:57], v22 offset:4608
    ds_read_b64_tr_b16 v[58:59], v22 offset:5184
    ds_read_b128 v[60:63], v26 offset:0
    ds_read_b64_tr_b16 v[64:65], v22 offset:6912
    ds_read_b64_tr_b16 v[66:67], v22 offset:7488
    ds_read_b128 v[68:71], v27 offset:0
    s_waitcnt lgkmcnt(9)
    v_mfma_f32_32x32x16_bf16 v[72:87], v[40:43], v[44:47], v[72:87]
    s_waitcnt lgkmcnt(6)
    v_mfma_f32_32x32x16_bf16 v[72:87], v[48:51], v[52:55], v[72:87]
    s_waitcnt lgkmcnt(3)
    v_mfma_f32_32x32x16_bf16 v[72:87], v[56:59], v[60:63], v[72:87]
    s_waitcnt lgkmcnt(0)
    v_mfma_f32_32x32x16_bf16 v[72:87], v[64:67], v[68:71], v[72:87]
    s_nop 10
    s_mov_b32 s29, 1051597459
    v_mul_f32 v72, s29, v72
    v_mul_f32 v73, s29, v73
    v_mul_f32 v74, s29, v74
    v_mul_f32 v75, s29, v75
    v_mul_f32 v76, s29, v76
    v_mul_f32 v77, s29, v77
    v_mul_f32 v78, s29, v78
    v_mul_f32 v79, s29, v79
    v_mul_f32 v80, s29, v80
    v_mul_f32 v81, s29, v81
    v_mul_f32 v82, s29, v82
    v_mul_f32 v83, s29, v83
    v_mul_f32 v84, s29, v84
    v_mul_f32 v85, s29, v85
    v_mul_f32 v86, s29, v86
    v_mul_f32 v87, s29, v87
    v_cvt_pk_bf16_f32 v32, v72, v73
    v_cvt_pk_bf16_f32 v33, v74, v75
    v_cvt_pk_bf16_f32 v34, v76, v77
    v_cvt_pk_bf16_f32 v35, v78, v79
    v_cvt_pk_bf16_f32 v36, v80, v81
    v_cvt_pk_bf16_f32 v37, v82, v83
    v_cvt_pk_bf16_f32 v38, v84, v85
    v_cvt_pk_bf16_f32 v39, v86, v87
    ds_write_b64 v12, v[32:33] offset:0
    ds_write_b64 v12, v[34:35] offset:16
    ds_write_b64 v12, v[36:37] offset:32
    ds_write_b64 v12, v[38:39] offset:48
    s_waitcnt lgkmcnt(0)
L_q_add:
    s_mov_b64 exec, 1
    ds_add_u32 v160, v161 offset:32
    s_mov_b64 exec, -1
L_q_done:
    s_mov_b32 s80, s10
    s_and_b32 s81, s11, 0xffff
    s_mov_b32 s82, 663552
    s_mov_b32 s83, 0x00020000
    s_mov_b32 s84, s8
    s_and_b32 s85, s9, 0xffff
    s_mov_b32 s86, 2359296
    s_mov_b32 s87, 0x00020000
    s_cmp_ge_u32 s24, 8
    s_cbranch_scc1 L_helper
    s_mov_b32 s93, 0
    s_branch L_cwe_89
L_cw_87:
    s_sleep 1
L_cwe_89:
    ds_read_b32 v15, v160 offset:32
    s_add_u32 s93, s93, 1
    s_waitcnt lgkmcnt(0)
    v_readfirstlane_b32 s100, v15
    s_cmp_ge_u32 s93, 1280000
    s_cbranch_scc1 L_cwd_88
    s_cmp_lt_u32 s100, 11
    s_cbranch_scc1 L_cw_87
L_cwd_88:
    v_and_b32 v11, 31, v1
    v_lshrrev_b32 v12, 5, v1
    v_mul_u32_u24 v13, 152, v11
    s_mul_i32 s29, s37, 18
    s_add_u32 s29, s29, 40960
    v_add_u32 v13, s29, v13
    v_lshl_add_u32 v14, v12, 4, v13
    v_add_u32 v15, 4864, v14
    ds_read2_b32 v[104:105], v14 offset0:0 offset1:1
    ds_read2_b32 v[106:107], v14 offset0:2 offset1:3
    ds_read_b32 v32, v13 offset:32
    ds_read2_b32 v[148:149], v15 offset0:0 offset1:1
    ds_read2_b32 v[150:151], v15 offset0:2 offset1:3
    ds_read_b32 v33, v13 offset:4896
    ds_read_b128 v[16:19], v2 offset:0
    ds_read_b64 v[20:21], v4 offset:8192
    ds_read_b128 v[24:27], v6 offset:9216
    v_mov_b32 v132, -1
    v_mov_b32 v133, -1
    v_mov_b32 v134, -1
    v_mov_b32 v135, -1
    v_mov_b32 v136, -1
    buffer_store_dwordx4 v[132:135], v8, s[12:15], s34 offen sc1
    s_mov_b32 exec_hi, 0
    buffer_store_dword v136, v8, s[12:15], s35 offen sc1
    s_mov_b32 exec_hi, -1
    v_mov_b32 v109, 0
    v_mov_b32 v110, 0
    v_mov_b32 v113, 0
    v_mov_b32 v114, 0
    v_mov_b32 v72, 0
    v_mov_b32 v73, 0
    v_mov_b32 v74, 0
    v_mov_b32 v75, 0
    v_mov_b32 v76, 0
    v_mov_b32 v77, 0
    v_mov_b32 v78, 0
    v_mov_b32 v79, 0
    v_mov_b32 v80, 0
    v_mov_b32 v81, 0
    v_mov_b32 v82, 0
    v_mov_b32 v83, 0
    v_mov_b32 v84, 0
    v_mov_b32 v85, 0
    v_mov_b32 v86, 0
    v_mov_b32 v87, 0
    v_mov_b32 v153, 0
    v_mov_b32 v154, 0
    v_mov_b32 v157, 0
    v_mov_b32 v158, 0
    v_mov_b32 v116, 0
    v_mov_b32 v117, 0
    v_mov_b32 v118, 0
    v_mov_b32 v119, 0
    v_mov_b32 v120, 0
    v_mov_b32 v121, 0
    v_mov_b32 v122, 0
    v_mov_b32 v123, 0
    v_mov_b32 v124, 0
    v_mov_b32 v125, 0
    v_mov_b32 v126, 0
    v_mov_b32 v127, 0
    v_mov_b32 v128, 0
    v_mov_b32 v129, 0
    v_mov_b32 v130, 0
    v_mov_b32 v131, 0
    v_mov_b32 v36, 0
    v_mov_b32 v28, 0
    v_mov_b32 v37, 0
    v_mov_b32 v29, 0
    v_mov_b32 v38, 0
    v_mov_b32 v30, 0
    v_mov_b32 v39, 0
    v_mov_b32 v31, 0
    s_waitcnt lgkmcnt(1)
    s_mov_b64 exec, 1
    ds_add_u32 v160, v161 offset:24
    s_mov_b64 exec, -1
    v_cndmask_b32 v108, v32, 0, s[30:31]
    v_cndmask_b32 v111, v32, 0, s[30:31]
    v_cndmask_b32 v112, 0, v32, s[30:31]
    v_cndmask_b32 v115, 0, v32, s[30:31]
    v_cndmask_b32 v152, v33, 0, s[30:31]
    v_cndmask_b32 v155, v33, 0, s[30:31]
    v_cndmask_b32 v156, 0, v33, s[30:31]
    v_cndmask_b32 v159, 0, v33, s[30:31]
    v_mfma_f32_32x32x16_bf16 v[40:55], v[16:19], v[104:107], 0
    v_mfma_f32_32x32x8_bf16 v[40:55], v[20:21], v[108:109], v[40:55]
    v_mfma_f32_32x32x16_bf16 v[56:71], v[16:19], v[148:151], 0
    v_mfma_f32_32x32x8_bf16 v[56:71], v[20:21], v[152:153], v[56:71]
    s_nop 9
    v_max3_f32 v11, v40, v41, v42
    v_max_f32 v11, v11, v43
    v_max3_f32 v11, v11, v44, v45
    v_max3_f32 v11, v11, v46, v47
    v_max3_f32 v11, v11, v48, v49
    v_max3_f32 v11, v11, v50, v51
    v_max3_f32 v11, v11, v52, v53
    v_max3_f32 v11, v11, v54, v55
    v_max3_f32 v13, v56, v57, v58
    v_max_f32 v13, v13, v59
    v_max3_f32 v13, v13, v60, v61
    v_max3_f32 v13, v13, v62, v63
    v_max3_f32 v13, v13, v64, v65
    v_max3_f32 v13, v13, v66, v67
    v_max3_f32 v13, v13, v68, v69
    v_max3_f32 v13, v13, v70, v71
    v_mov_b32 v12, v11
    v_mov_b32 v14, v13
    s_nop 0
    v_permlane32_swap_b32 v11, v12
    v_permlane32_swap_b32 v13, v14
    s_nop 0
    v_max_f32 v11, v11, v12
    v_max_f32 v13, v13, v14
    v_sub_f32 v88, 0, v11
    v_sub_f32 v89, 0, v11
    v_sub_f32 v90, 0, v11
    v_sub_f32 v91, 0, v11
    v_sub_f32 v92, 0, v11
    v_sub_f32 v93, 0, v11
    v_sub_f32 v94, 0, v11
    v_sub_f32 v95, 0, v11
    v_sub_f32 v96, 0, v11
    v_sub_f32 v97, 0, v11
    v_sub_f32 v98, 0, v11
    v_sub_f32 v99, 0, v11
    v_sub_f32 v100, 0, v11
    v_sub_f32 v101, 0, v11
    v_sub_f32 v102, 0, v11
    v_sub_f32 v103, 0, v11
    v_sub_f32 v132, 0, v13
    v_sub_f32 v133, 0, v13
    v_sub_f32 v134, 0, v13
    v_sub_f32 v135, 0, v13
    v_sub_f32 v136, 0, v13
    v_sub_f32 v137, 0, v13
    v_sub_f32 v138, 0, v13
    v_sub_f32 v139, 0, v13
    v_sub_f32 v140, 0, v13
    v_sub_f32 v141, 0, v13
    v_sub_f32 v142, 0, v13
    v_sub_f32 v143, 0, v13
    v_sub_f32 v144, 0, v13
    v_sub_f32 v145, 0, v13
    v_sub_f32 v146, 0, v13
    v_sub_f32 v147, 0, v13
    v_sub_f32 v40, v40, v11
    v_sub_f32 v41, v41, v11
    v_sub_f32 v42, v42, v11
    v_sub_f32 v43, v43, v11
    v_sub_f32 v44, v44, v11
    v_sub_f32 v45, v45, v11
    v_sub_f32 v46, v46, v11
    v_sub_f32 v47, v47, v11
    v_sub_f32 v48, v48, v11
    v_sub_f32 v49, v49, v11
    v_sub_f32 v50, v50, v11
    v_sub_f32 v51, v51, v11
    v_sub_f32 v52, v52, v11
    v_sub_f32 v53, v53, v11
    v_sub_f32 v54, v54, v11
    v_sub_f32 v55, v55, v11
    s_waitcnt lgkmcnt(0)
.p2align 3
L_attn_loop:
    s_setprio 2
    v_exp_f32 v40, v40
    v_exp_f32 v41, v41
    v_mfma_f32_32x32x16_bf16 v[116:131], v[28:31], v[36:39], v[116:131]
    ds_read_b128 v[28:31], v6 offset:9856
    v_exp_f32 v42, v42
    v_exp_f32 v43, v43
    v_exp_f32 v44, v44
    v_exp_f32 v45, v45
    v_exp_f32 v46, v46
    v_mfma_f32_32x32x16_bf16 v[56:71], v[16:19], v[148:151], v[132:147]
    ds_read_b128 v[16:19], v2 offset:1024
    v_exp_f32 v47, v47
    v_cvt_pk_bf16_f32 v32, v40, v41
    v_cvt_pk_bf16_f32 v33, v42, v43
    v_cvt_pk_bf16_f32 v34, v44, v45
    v_cvt_pk_bf16_f32 v35, v46, v47
    v_exp_f32 v48, v48
    v_exp_f32 v49, v49
    v_mfma_f32_32x32x8_bf16 v[56:71], v[20:21], v[152:153], v[56:71]
    v_exp_f32 v50, v50
    v_exp_f32 v51, v51
    v_exp_f32 v52, v52
    v_exp_f32 v53, v53
    v_exp_f32 v54, v54
    v_mfma_f32_32x32x16_bf16 v[72:87], v[24:27], v[32:35], v[72:87]
    v_exp_f32 v55, v55
    v_cvt_pk_bf16_f32 v36, v48, v49
    v_cvt_pk_bf16_f32 v37, v50, v51
    v_cvt_pk_bf16_f32 v38, v52, v53
    v_cvt_pk_bf16_f32 v39, v54, v55
    s_nop 0
    v_exp_f32 v56, v56
    v_exp_f32 v57, v57
    s_waitcnt lgkmcnt(1)
    v_mfma_f32_32x32x16_bf16 v[72:87], v[28:31], v[36:39], v[72:87]
    v_exp_f32 v58, v58
    v_exp_f32 v59, v59
    v_exp_f32 v60, v60
    v_exp_f32 v61, v61
    v_exp_f32 v62, v62
    s_waitcnt lgkmcnt(0)
    v_mfma_f32_32x32x16_bf16 v[40:55], v[16:19], v[104:107], v[88:103]
    v_exp_f32 v63, v63
    v_cvt_pk_bf16_f32 v32, v56, v57
    v_cvt_pk_bf16_f32 v33, v58, v59
    v_cvt_pk_bf16_f32 v34, v60, v61
    v_cvt_pk_bf16_f32 v35, v62, v63
    v_exp_f32 v64, v64
    v_exp_f32 v65, v65
    v_mfma_f32_32x32x8_bf16 v[40:55], v[20:21], v[110:111], v[40:55]
    v_exp_f32 v66, v66
    v_exp_f32 v67, v67
    v_exp_f32 v68, v68
    v_exp_f32 v69, v69
    v_exp_f32 v70, v70
    v_mfma_f32_32x32x16_bf16 v[116:131], v[24:27], v[32:35], v[116:131]
    ds_read_b128 v[24:27], v6 offset:10496
    v_exp_f32 v71, v71
    v_cvt_pk_bf16_f32 v36, v64, v65
    v_cvt_pk_bf16_f32 v37, v66, v67
    v_cvt_pk_bf16_f32 v38, v68, v69
    v_cvt_pk_bf16_f32 v39, v70, v71
    v_exp_f32 v40, v40
    v_exp_f32 v41, v41
    v_mfma_f32_32x32x16_bf16 v[116:131], v[28:31], v[36:39], v[116:131]
    ds_read_b128 v[28:31], v6 offset:11136
    v_exp_f32 v42, v42
    v_exp_f32 v43, v43
    v_exp_f32 v44, v44
    v_exp_f32 v45, v45
    v_exp_f32 v46, v46
    v_mfma_f32_32x32x16_bf16 v[56:71], v[16:19], v[148:151], v[132:147]
    ds_read_b128 v[16:19], v2 offset:2048
    v_exp_f32 v47, v47
    v_cvt_pk_bf16_f32 v32, v40, v41
    v_cvt_pk_bf16_f32 v33, v42, v43
    v_cvt_pk_bf16_f32 v34, v44, v45
    v_cvt_pk_bf16_f32 v35, v46, v47
    v_exp_f32 v48, v48
    v_exp_f32 v49, v49
    v_mfma_f32_32x32x8_bf16 v[56:71], v[20:21], v[154:155], v[56:71]
    v_exp_f32 v50, v50
    v_exp_f32 v51, v51
    v_exp_f32 v52, v52
    v_exp_f32 v53, v53
    v_exp_f32 v54, v54
    s_waitcnt lgkmcnt(2)
    v_mfma_f32_32x32x16_bf16 v[72:87], v[24:27], v[32:35], v[72:87]
    v_exp_f32 v55, v55
    v_cvt_pk_bf16_f32 v36, v48, v49
    v_cvt_pk_bf16_f32 v37, v50, v51
    v_cvt_pk_bf16_f32 v38, v52, v53
    v_cvt_pk_bf16_f32 v39, v54, v55
    v_exp_f32 v56, v56
    v_exp_f32 v57, v57
    s_waitcnt lgkmcnt(1)
    v_mfma_f32_32x32x16_bf16 v[72:87], v[28:31], v[36:39], v[72:87]
    v_exp_f32 v58, v58
    v_exp_f32 v59, v59
    v_exp_f32 v60, v60
    v_exp_f32 v61, v61
    v_exp_f32 v62, v62
    s_waitcnt lgkmcnt(0)
    v_mfma_f32_32x32x16_bf16 v[40:55], v[16:19], v[104:107], v[88:103]
    v_exp_f32 v63, v63
    v_cvt_pk_bf16_f32 v32, v56, v57
    v_cvt_pk_bf16_f32 v33, v58, v59
    v_cvt_pk_bf16_f32 v34, v60, v61
    v_cvt_pk_bf16_f32 v35, v62, v63
    v_exp_f32 v64, v64
    v_exp_f32 v65, v65
    v_mfma_f32_32x32x8_bf16 v[40:55], v[20:21], v[112:113], v[40:55]
    v_exp_f32 v66, v66
    v_exp_f32 v67, v67
    v_exp_f32 v68, v68
    v_exp_f32 v69, v69
    v_exp_f32 v70, v70
    v_mfma_f32_32x32x16_bf16 v[116:131], v[24:27], v[32:35], v[116:131]
    ds_read_b128 v[24:27], v6 offset:11776
    v_exp_f32 v71, v71
    v_cvt_pk_bf16_f32 v36, v64, v65
    v_cvt_pk_bf16_f32 v37, v66, v67
    v_cvt_pk_bf16_f32 v38, v68, v69
    v_cvt_pk_bf16_f32 v39, v70, v71
    s_call_b64 s[62:63], L_siteC
    v_exp_f32 v40, v40
    v_exp_f32 v41, v41
    v_mfma_f32_32x32x16_bf16 v[116:131], v[28:31], v[36:39], v[116:131]
    ds_read_b128 v[28:31], v6 offset:12416
    v_exp_f32 v42, v42
    v_exp_f32 v43, v43
    v_exp_f32 v44, v44
    v_exp_f32 v45, v45
    v_exp_f32 v46, v46
    v_mfma_f32_32x32x16_bf16 v[56:71], v[16:19], v[148:151], v[132:147]
    ds_read_b128 v[16:19], v2 offset:3072
    ds_read_b64 v[22:23], v4 offset:27648
    s_cmp_eq_u32 s23, 0
    s_cbranch_scc1 L_ds_90
    s_mov_b32 m0, s38
    s_sub_u32 s23, s23, 1
    buffer_load_dwordx4 v8, s[12:15], s28 offen sc1 lds
    s_add_u32 s38, s38, 8192
    s_add_u32 s28, s28, 8192
L_ds_90:
    v_exp_f32 v47, v47
    v_cvt_pk_bf16_f32 v32, v40, v41
    v_cvt_pk_bf16_f32 v33, v42, v43
    v_cvt_pk_bf16_f32 v34, v44, v45
    v_cvt_pk_bf16_f32 v35, v46, v47
    v_exp_f32 v48, v48
    v_exp_f32 v49, v49
    v_mfma_f32_32x32x8_bf16 v[56:71], v[20:21], v[156:157], v[56:71]
    v_exp_f32 v50, v50
    v_exp_f32 v51, v51
    v_exp_f32 v52, v52
    v_exp_f32 v53, v53
    v_exp_f32 v54, v54
    s_waitcnt lgkmcnt(3)
    v_mfma_f32_32x32x16_bf16 v[72:87], v[24:27], v[32:35], v[72:87]
    v_exp_f32 v55, v55
    v_cvt_pk_bf16_f32 v36, v48, v49
    v_cvt_pk_bf16_f32 v37, v50, v51
    v_cvt_pk_bf16_f32 v38, v52, v53
    v_cvt_pk_bf16_f32 v39, v54, v55
    v_exp_f32 v56, v56
    v_exp_f32 v57, v57
    s_waitcnt lgkmcnt(2)
    v_mfma_f32_32x32x16_bf16 v[72:87], v[28:31], v[36:39], v[72:87]
    v_exp_f32 v58, v58
    v_exp_f32 v59, v59
    v_exp_f32 v60, v60
    v_exp_f32 v61, v61
    v_exp_f32 v62, v62
    s_waitcnt lgkmcnt(1)
    v_mfma_f32_32x32x16_bf16 v[40:55], v[16:19], v[104:107], v[88:103]
    s_cmp_eq_u32 s23, 0
    s_cbranch_scc1 L_ds_91
    s_mov_b32 m0, s38
    s_sub_u32 s23, s23, 1
    buffer_load_dwordx4 v8, s[12:15], s28 offen sc1 lds
    s_add_u32 s38, s38, 8192
    s_add_u32 s28, s28, 8192
L_ds_91:
    v_exp_f32 v63, v63
    v_cvt_pk_bf16_f32 v32, v56, v57
    v_cvt_pk_bf16_f32 v33, v58, v59
    v_cvt_pk_bf16_f32 v34, v60, v61
    v_cvt_pk_bf16_f32 v35, v62, v63
    v_exp_f32 v64, v64
    v_exp_f32 v65, v65
    v_mfma_f32_32x32x8_bf16 v[40:55], v[20:21], v[114:115], v[40:55]
    v_exp_f32 v66, v66
    v_exp_f32 v67, v67
    v_exp_f32 v68, v68
    v_exp_f32 v69, v69
    v_exp_f32 v70, v70
    v_mfma_f32_32x32x16_bf16 v[116:131], v[24:27], v[32:35], v[116:131]
    ds_read_b128 v[24:27], v6 offset:13056
    v_exp_f32 v71, v71
    v_cvt_pk_bf16_f32 v36, v64, v65
    v_cvt_pk_bf16_f32 v37, v66, v67
    v_cvt_pk_bf16_f32 v38, v68, v69
    v_cvt_pk_bf16_f32 v39, v70, v71
    v_exp_f32 v40, v40
    v_exp_f32 v41, v41
    v_mfma_f32_32x32x16_bf16 v[116:131], v[28:31], v[36:39], v[116:131]
    ds_read_b128 v[28:31], v6 offset:13696
    v_exp_f32 v42, v42
    v_exp_f32 v43, v43
    v_exp_f32 v44, v44
    v_exp_f32 v45, v45
    v_exp_f32 v46, v46
    v_mfma_f32_32x32x16_bf16 v[56:71], v[16:19], v[148:151], v[132:147]
    ds_read_b128 v[16:19], v2 offset:19456
    s_cmp_eq_u32 s23, 0
    s_cbranch_scc1 L_ds_92
    s_mov_b32 m0, s38
    s_sub_u32 s23, s23, 1
    buffer_load_dwordx4 v8, s[12:15], s28 offen sc1 lds
    s_add_u32 s38, s38, 8192
    s_add_u32 s28, s28, 8192
L_ds_92:
    v_exp_f32 v47, v47
    v_cvt_pk_bf16_f32 v32, v40, v41
    v_cvt_pk_bf16_f32 v33, v42, v43
    v_cvt_pk_bf16_f32 v34, v44, v45
    v_cvt_pk_bf16_f32 v35, v46, v47
    v_exp_f32 v48, v48
    v_exp_f32 v49, v49
    v_mfma_f32_32x32x8_bf16 v[56:71], v[20:21], v[158:159], v[56:71]
    v_exp_f32 v50, v50
    v_exp_f32 v51, v51
    v_exp_f32 v52, v52
    v_exp_f32 v53, v53
    v_exp_f32 v54, v54
    s_waitcnt lgkmcnt(2)
    v_mfma_f32_32x32x16_bf16 v[72:87], v[24:27], v[32:35], v[72:87]
    v_exp_f32 v55, v55
    v_cvt_pk_bf16_f32 v36, v48, v49
    v_cvt_pk_bf16_f32 v37, v50, v51
    v_cvt_pk_bf16_f32 v38, v52, v53
    v_cvt_pk_bf16_f32 v39, v54, v55
    v_exp_f32 v56, v56
    v_exp_f32 v57, v57
    s_waitcnt lgkmcnt(1)
    v_mfma_f32_32x32x16_bf16 v[72:87], v[28:31], v[36:39], v[72:87]
    v_exp_f32 v58, v58
    v_exp_f32 v59, v59
    v_exp_f32 v60, v60
    v_exp_f32 v61, v61
    v_exp_f32 v62, v62
    s_waitcnt lgkmcnt(0)
    v_mfma_f32_32x32x16_bf16 v[40:55], v[16:19], v[104:107], v[88:103]
    v_exp_f32 v63, v63
    v_cvt_pk_bf16_f32 v32, v56, v57
    v_cvt_pk_bf16_f32 v33, v58, v59
    v_cvt_pk_bf16_f32 v34, v60, v61
    v_cvt_pk_bf16_f32 v35, v62, v63
    v_exp_f32 v64, v64
    v_exp_f32 v65, v65
    v_mfma_f32_32x32x8_bf16 v[40:55], v[22:23], v[108:109], v[40:55]
    v_exp_f32 v66, v66
    v_exp_f32 v67, v67
    v_exp_f32 v68, v68
    v_exp_f32 v69, v69
    v_exp_f32 v70, v70
    v_mfma_f32_32x32x16_bf16 v[116:131], v[24:27], v[32:35], v[116:131]
    ds_read_b128 v[24:27], v6 offset:28672
    v_exp_f32 v71, v71
    v_cvt_pk_bf16_f32 v36, v64, v65
    v_cvt_pk_bf16_f32 v37, v66, v67
    v_cvt_pk_bf16_f32 v38, v68, v69
    v_cvt_pk_bf16_f32 v39, v70, v71
    s_add_u32 s27, s27, 1
    s_waitcnt vmcnt(2)
    s_waitcnt lgkmcnt(0)
    s_mov_b64 exec, 1
    ds_add_u32 v160, v161 offset:24
    s_mov_b64 exec, -1
    s_setprio 1
    v_exp_f32 v40, v40
    v_exp_f32 v41, v41
    v_mfma_f32_32x32x16_bf16 v[116:131], v[28:31], v[36:39], v[116:131]
    ds_read_b128 v[28:31], v6 offset:29312
    v_exp_f32 v42, v42
    v_exp_f32 v43, v43
    v_exp_f32 v44, v44
    v_exp_f32 v45, v45
    v_exp_f32 v46, v46
    v_mfma_f32_32x32x16_bf16 v[56:71], v[16:19], v[148:151], v[132:147]
    ds_read_b128 v[16:19], v2 offset:20480
    v_exp_f32 v47, v47
    v_cvt_pk_bf16_f32 v32, v40, v41
    v_cvt_pk_bf16_f32 v33, v42, v43
    v_cvt_pk_bf16_f32 v34, v44, v45
    v_cvt_pk_bf16_f32 v35, v46, v47
    v_exp_f32 v48, v48
    v_exp_f32 v49, v49
    v_mfma_f32_32x32x8_bf16 v[56:71], v[22:23], v[152:153], v[56:71]
    v_exp_f32 v50, v50
    v_exp_f32 v51, v51
    v_exp_f32 v52, v52
    v_exp_f32 v53, v53
    v_exp_f32 v54, v54
    v_mfma_f32_32x32x16_bf16 v[72:87], v[24:27], v[32:35], v[72:87]
    v_exp_f32 v55, v55
    v_cvt_pk_bf16_f32 v36, v48, v49
    v_cvt_pk_bf16_f32 v37, v50, v51
    v_cvt_pk_bf16_f32 v38, v52, v53
    v_cvt_pk_bf16_f32 v39, v54, v55
    s_nop 0
    v_exp_f32 v56, v56
    v_exp_f32 v57, v57
    s_waitcnt lgkmcnt(1)
    v_mfma_f32_32x32x16_bf16 v[72:87], v[28:31], v[36:39], v[72:87]
    v_exp_f32 v58, v58
    v_exp_f32 v59, v59
    v_exp_f32 v60, v60
    v_exp_f32 v61, v61
    v_exp_f32 v62, v62
    s_waitcnt lgkmcnt(0)
    v_mfma_f32_32x32x16_bf16 v[40:55], v[16:19], v[104:107], v[88:103]
    v_exp_f32 v63, v63
    v_cvt_pk_bf16_f32 v32, v56, v57
    v_cvt_pk_bf16_f32 v33, v58, v59
    v_cvt_pk_bf16_f32 v34, v60, v61
    v_cvt_pk_bf16_f32 v35, v62, v63
    v_exp_f32 v64, v64
    v_exp_f32 v65, v65
    v_mfma_f32_32x32x8_bf16 v[40:55], v[22:23], v[110:111], v[40:55]
    v_exp_f32 v66, v66
    v_exp_f32 v67, v67
    v_exp_f32 v68, v68
    v_exp_f32 v69, v69
    v_exp_f32 v70, v70
    v_mfma_f32_32x32x16_bf16 v[116:131], v[24:27], v[32:35], v[116:131]
    ds_read_b128 v[24:27], v6 offset:29952
    v_exp_f32 v71, v71
    v_cvt_pk_bf16_f32 v36, v64, v65
    v_cvt_pk_bf16_f32 v37, v66, v67
    v_cvt_pk_bf16_f32 v38, v68, v69
    v_cvt_pk_bf16_f32 v39, v70, v71
    v_exp_f32 v40, v40
    v_exp_f32 v41, v41
    v_mfma_f32_32x32x16_bf16 v[116:131], v[28:31], v[36:39], v[116:131]
    ds_read_b128 v[28:31], v6 offset:30592
    v_exp_f32 v42, v42
    v_exp_f32 v43, v43
    v_exp_f32 v44, v44
    v_exp_f32 v45, v45
    v_exp_f32 v46, v46
    v_mfma_f32_32x32x16_bf16 v[56:71], v[16:19], v[148:151], v[132:147]
    ds_read_b128 v[16:19], v2 offset:21504
    v_exp_f32 v47, v47
    v_cvt_pk_bf16_f32 v32, v40, v41
    v_cvt_pk_bf16_f32 v33, v42, v43
    v_cvt_pk_bf16_f32 v34, v44, v45
    v_cvt_pk_bf16_f32 v35, v46, v47
    v_exp_f32 v48, v48
    v_exp_f32 v49, v49
    v_mfma_f32_32x32x8_bf16 v[56:71], v[22:23], v[154:155], v[56:71]
    v_exp_f32 v50, v50
    v_exp_f32 v51, v51
    v_exp_f32 v52, v52
    v_exp_f32 v53, v53
    v_exp_f32 v54, v54
    s_waitcnt lgkmcnt(2)
    v_mfma_f32_32x32x16_bf16 v[72:87], v[24:27], v[32:35], v[72:87]
    v_exp_f32 v55, v55
    v_cvt_pk_bf16_f32 v36, v48, v49
    v_cvt_pk_bf16_f32 v37, v50, v51
    v_cvt_pk_bf16_f32 v38, v52, v53
    v_cvt_pk_bf16_f32 v39, v54, v55
    v_exp_f32 v56, v56
    v_exp_f32 v57, v57
    s_waitcnt lgkmcnt(1)
    v_mfma_f32_32x32x16_bf16 v[72:87], v[28:31], v[36:39], v[72:87]
    v_exp_f32 v58, v58
    v_exp_f32 v59, v59
    v_exp_f32 v60, v60
    v_exp_f32 v61, v61
    v_exp_f32 v62, v62
    s_waitcnt lgkmcnt(0)
    v_mfma_f32_32x32x16_bf16 v[40:55], v[16:19], v[104:107], v[88:103]
    v_exp_f32 v63, v63
    v_cvt_pk_bf16_f32 v32, v56, v57
    v_cvt_pk_bf16_f32 v33, v58, v59
    v_cvt_pk_bf16_f32 v34, v60, v61
    v_cvt_pk_bf16_f32 v35, v62, v63
    v_exp_f32 v64, v64
    v_exp_f32 v65, v65
    v_mfma_f32_32x32x8_bf16 v[40:55], v[22:23], v[112:113], v[40:55]
    v_exp_f32 v66, v66
    v_exp_f32 v67, v67
    v_exp_f32 v68, v68
    v_exp_f32 v69, v69
    v_exp_f32 v70, v70
    v_mfma_f32_32x32x16_bf16 v[116:131], v[24:27], v[32:35], v[116:131]
    ds_read_b128 v[24:27], v6 offset:31232
    v_exp_f32 v71, v71
    v_cvt_pk_bf16_f32 v36, v64, v65
    v_cvt_pk_bf16_f32 v37, v66, v67
    v_cvt_pk_bf16_f32 v38, v68, v69
    v_cvt_pk_bf16_f32 v39, v70, v71
    s_call_b64 s[62:63], L_siteC
    v_exp_f32 v40, v40
    v_exp_f32 v41, v41
    v_mfma_f32_32x32x16_bf16 v[116:131], v[28:31], v[36:39], v[116:131]
    ds_read_b128 v[28:31], v6 offset:31872
    v_exp_f32 v42, v42
    v_exp_f32 v43, v43
    v_exp_f32 v44, v44
    v_exp_f32 v45, v45
    v_exp_f32 v46, v46
    v_mfma_f32_32x32x16_bf16 v[56:71], v[16:19], v[148:151], v[132:147]
    ds_read_b128 v[16:19], v2 offset:22528
    ds_read_b64 v[20:21], v5 offset:8192
    s_cmp_eq_u32 s23, 0
    s_cbranch_scc1 L_ds_93
    s_mov_b32 m0, s38
    s_sub_u32 s23, s23, 1
    buffer_load_dwordx4 v8, s[12:15], s28 offen sc1 lds
    s_add_u32 s38, s38, 8192
    s_add_u32 s28, s28, 8192
L_ds_93:
    v_exp_f32 v47, v47
    v_cvt_pk_bf16_f32 v32, v40, v41
    v_cvt_pk_bf16_f32 v33, v42, v43
    v_cvt_pk_bf16_f32 v34, v44, v45
    v_cvt_pk_bf16_f32 v35, v46, v47
    v_exp_f32 v48, v48
    v_exp_f32 v49, v49
    v_mfma_f32_32x32x8_bf16 v[56:71], v[22:23], v[156:157], v[56:71]
    v_exp_f32 v50, v50
    v_exp_f32 v51, v51
    v_exp_f32 v52, v52
    v_exp_f32 v53, v53
    v_exp_f32 v54, v54
    s_waitcnt lgkmcnt(3)
    v_mfma_f32_32x32x16_bf16 v[72:87], v[24:27], v[32:35], v[72:87]
    v_exp_f32 v55, v55
    v_cvt_pk_bf16_f32 v36, v48, v49
    v_cvt_pk_bf16_f32 v37, v50, v51
    v_cvt_pk_bf16_f32 v38, v52, v53
    v_cvt_pk_bf16_f32 v39, v54, v55
    s_setprio 0
    v_exp_f32 v56, v56
    v_exp_f32 v57, v57
    s_waitcnt lgkmcnt(2)
    v_mfma_f32_32x32x16_bf16 v[72:87], v[28:31], v[36:39], v[72:87]
    v_exp_f32 v58, v58
    v_exp_f32 v59, v59
    v_exp_f32 v60, v60
    v_exp_f32 v61, v61
    v_exp_f32 v62, v62
    s_waitcnt lgkmcnt(1)
    v_mfma_f32_32x32x16_bf16 v[40:55], v[16:19], v[104:107], v[88:103]
    s_cmp_eq_u32 s23, 0
    s_cbranch_scc1 L_ds_94
    s_mov_b32 m0, s38
    s_sub_u32 s23, s23, 1
    buffer_load_dwordx4 v8, s[12:15], s28 offen sc1 lds
    s_add_u32 s38, s38, 8192
    s_add_u32 s28, s28, 8192
L_ds_94:
    v_exp_f32 v63, v63
    v_cvt_pk_bf16_f32 v32, v56, v57
    v_cvt_pk_bf16_f32 v33, v58, v59
    v_cvt_pk_bf16_f32 v34, v60, v61
    v_cvt_pk_bf16_f32 v35, v62, v63
    v_exp_f32 v64, v64
    v_exp_f32 v65, v65
    v_mfma_f32_32x32x8_bf16 v[40:55], v[22:23], v[114:115], v[40:55]
    v_exp_f32 v66, v66
    v_exp_f32 v67, v67
    v_exp_f32 v68, v68
    v_exp_f32 v69, v69
    v_exp_f32 v70, v70
    v_mfma_f32_32x32x16_bf16 v[116:131], v[24:27], v[32:35], v[116:131]
    ds_read_b128 v[24:27], v6 offset:32512
    v_exp_f32 v71, v71
    v_cvt_pk_bf16_f32 v36, v64, v65
    v_cvt_pk_bf16_f32 v37, v66, v67
    v_cvt_pk_bf16_f32 v38, v68, v69
    v_cvt_pk_bf16_f32 v39, v70, v71
    v_exp_f32 v40, v40
    v_exp_f32 v41, v41
    v_mfma_f32_32x32x16_bf16 v[116:131], v[28:31], v[36:39], v[116:131]
    ds_read_b128 v[28:31], v6 offset:33152
    v_exp_f32 v42, v42
    v_exp_f32 v43, v43
    v_exp_f32 v44, v44
    v_exp_f32 v45, v45
    v_exp_f32 v46, v46
    v_mfma_f32_32x32x16_bf16 v[56:71], v[16:19], v[148:151], v[132:147]
    ds_read_b128 v[16:19], v3 offset:0
    s_cmp_eq_u32 s23, 0
    s_cbranch_scc1 L_ds_95
    s_mov_b32 m0, s38
    s_sub_u32 s23, s23, 1
    buffer_load_dwordx4 v8, s[12:15], s28 offen sc1 lds
    s_add_u32 s38, s38, 8192
    s_add_u32 s28, s28, 8192
L_ds_95:
    v_exp_f32 v47, v47
    v_cvt_pk_bf16_f32 v32, v40, v41
    v_cvt_pk_bf16_f32 v33, v42, v43
    v_cvt_pk_bf16_f32 v34, v44, v45
    v_cvt_pk_bf16_f32 v35, v46, v47
    v_exp_f32 v48, v48
    v_exp_f32 v49, v49
    v_mfma_f32_32x32x8_bf16 v[56:71], v[22:23], v[158:159], v[56:71]
    v_exp_f32 v50, v50
    v_exp_f32 v51, v51
    v_exp_f32 v52, v52
    v_exp_f32 v53, v53
    v_exp_f32 v54, v54
    s_waitcnt lgkmcnt(2)
    v_mfma_f32_32x32x16_bf16 v[72:87], v[24:27], v[32:35], v[72:87]
    v_exp_f32 v55, v55
    v_cvt_pk_bf16_f32 v36, v48, v49
    v_cvt_pk_bf16_f32 v37, v50, v51
    v_cvt_pk_bf16_f32 v38, v52, v53
    v_cvt_pk_bf16_f32 v39, v54, v55
    v_exp_f32 v56, v56
    v_exp_f32 v57, v57
    s_waitcnt lgkmcnt(1)
    v_mfma_f32_32x32x16_bf16 v[72:87], v[28:31], v[36:39], v[72:87]
    v_exp_f32 v58, v58
    v_exp_f32 v59, v59
    v_exp_f32 v60, v60
    v_exp_f32 v61, v61
    v_exp_f32 v62, v62
    s_waitcnt lgkmcnt(0)
    v_mfma_f32_32x32x16_bf16 v[40:55], v[16:19], v[104:107], v[88:103]
    v_exp_f32 v63, v63
    v_cvt_pk_bf16_f32 v32, v56, v57
    v_cvt_pk_bf16_f32 v33, v58, v59
    v_cvt_pk_bf16_f32 v34, v60, v61
    v_cvt_pk_bf16_f32 v35, v62, v63
    v_exp_f32 v64, v64
    v_exp_f32 v65, v65
    v_mfma_f32_32x32x8_bf16 v[40:55], v[20:21], v[108:109], v[40:55]
    v_exp_f32 v66, v66
    v_exp_f32 v67, v67
    v_exp_f32 v68, v68
    v_exp_f32 v69, v69
    v_exp_f32 v70, v70
    v_mfma_f32_32x32x16_bf16 v[116:131], v[24:27], v[32:35], v[116:131]
    ds_read_b128 v[24:27], v7 offset:9216
    v_exp_f32 v71, v71
    v_cvt_pk_bf16_f32 v36, v64, v65
    v_cvt_pk_bf16_f32 v37, v66, v67
    v_cvt_pk_bf16_f32 v38, v68, v69
    v_cvt_pk_bf16_f32 v39, v70, v71
    s_add_u32 s27, s27, 1
    v_swap_b32 v3, v2
    v_swap_b32 v5, v4
    v_swap_b32 v7, v6
    s_waitcnt vmcnt(2) lgkmcnt(0)
    s_cmp_lt_u32 s27, 6
    s_cbranch_scc1 L_e6_96
    s_waitcnt vmcnt(0)
L_e6_96:
    s_mov_b64 exec, 1
    ds_add_u32 v160, v161 offset:24
    s_mov_b64 exec, -1
    s_waitcnt lgkmcnt(0)
    s_cmp_lt_u32 s27, 8
    s_cbranch_scc1 L_attn_loop
    s_setprio 3
    v_mfma_f32_32x32x16_bf16 v[116:131], v[28:31], v[36:39], v[116:131]
    s_mov_b32 s29, 0x4e800000
    s_nop 12
    v_cndmask_b32 v82, v82, v86, s[30:31]
    v_cndmask_b32 v126, v126, v130, s[30:31]
    v_add_f32 v11, v82, v126
    v_min_f32 v12, v82, v126
    s_mov_b32 s32, 0x35800000
    v_cmp_ngt_f32 vcc, s29, v11
    v_cmp_nle_f32 s[98:99], s32, v12
    s_nop 4
    s_or_b64 vcc, vcc, s[98:99]
    s_cbranch_vccnz L_fallback
L_attn_ok:
    v_mov_b32 v83, v88
    v_mov_b32 v127, v132
    s_xor_b32 s29, s36, 1
    s_add_u32 s29, s29, s37
    s_add_u32 s37, s37, s36
    s_mul_i32 s32, s29, 2560
    s_add_u32 s32, s32, 18432
    v_add_u32 v11, s32, v8
    s_mul_i32 s32, s37, 2560
    s_add_u32 s32, s32, 18432
    v_add_u32 v12, s32, v8
    v_and_b32 v13, 0x1ff, v8
    v_add_u32 v13, s32, v13
    s_lshl_b32 s29, s29, 2
    v_add_u32 v14, s29, v160
    s_mov_b32 s93, 0
    s_branch L_cwe_99
L_cw_97:
    s_sleep 1
L_cwe_99:
    ds_read_b32 v15, v160 offset:24
    s_add_u32 s93, s93, 1
    s_waitcnt lgkmcnt(0)
    v_readfirstlane_b32 s100, v15
    s_cmp_ge_u32 s93, 1280000
    s_cbranch_scc1 L_cwd_98
    s_cmp_lt_u32 s100, 56
    s_cbranch_scc1 L_cw_97
L_cwd_98:
L_kh0:
    s_cmp_eq_u32 s36, 1
    s_cbranch_scc1 L_kh1
    ds_write_b128 v11, v[116:119]
    ds_write_b128 v11, v[120:123] offset:1024
    s_mov_b32 exec_hi, 0
    ds_write_b128 v11, v[124:127] offset:2048
    s_mov_b32 exec_hi, -1
    v_mov_b32 v56, v72
    v_mov_b32 v57, v73
    v_mov_b32 v58, v74
    v_mov_b32 v59, v75
    v_mov_b32 v60, v76
    v_mov_b32 v61, v77
    v_mov_b32 v62, v78
    v_mov_b32 v63, v79
    v_mov_b32 v64, v80
    v_mov_b32 v65, v81
    v_mov_b32 v66, v82
    v_mov_b32 v67, v83
    s_branch L_khj
L_kh1:
    ds_write_b128 v11, v[72:75]
    ds_write_b128 v11, v[76:79] offset:1024
    s_mov_b32 exec_hi, 0
    ds_write_b128 v11, v[80:83] offset:2048
    s_mov_b32 exec_hi, -1
    v_mov_b32 v56, v116
    v_mov_b32 v57, v117
    v_mov_b32 v58, v118
    v_mov_b32 v59, v119
    v_mov_b32 v60, v120
    v_mov_b32 v61, v121
    v_mov_b32 v62, v122
    v_mov_b32 v63, v123
    v_mov_b32 v64, v124
    v_mov_b32 v65, v125
    v_mov_b32 v66, v126
    v_mov_b32 v67, v127
L_khj:
    s_waitcnt lgkmcnt(0)
    s_mov_b64 exec, 1
    ds_add_u32 v14, v161 offset:48
    s_mov_b64 exec, -1
    s_lshl_b32 s29, s37, 2
    v_add_u32 v160, s29, v160
    s_mov_b32 s93, 0
    s_branch L_cwe_102
L_cw_100:
    s_sleep 1
L_cwe_102:
    ds_read_b32 v15, v160 offset:48
    s_add_u32 s93, s93, 1
    s_waitcnt lgkmcnt(0)
    v_readfirstlane_b32 s100, v15
    s_cmp_ge_u32 s93, 1280000
    s_cbranch_scc1 L_cwd_101
    s_cmp_lt_u32 s100, 1
    s_cbranch_scc1 L_cw_100
L_cwd_101:
    v_mov_b32 v160, 162816
    ds_read_b128 v[48:51], v13 offset:2048
    ds_read_b128 v[40:43], v12
    ds_read_b128 v[44:47], v12 offset:1024
    s_waitcnt lgkmcnt(2)
    v_min_f32 v11, v67, v51
    v_sub_f32 v12, v11, v67
    v_sub_f32 v13, v11, v51
    v_exp_f32 v12, v12
    v_exp_f32 v13, v13
    s_nop 0
    v_mul_f32 v14, v66, v12
    v_fmac_f32 v14, v50, v13
    v_rcp_f32 v14, v14
    s_nop 0
    v_mul_f32 v12, v12, v14
    v_mul_f32 v13, v13, v14
    s_waitcnt lgkmcnt(0)
    v_mul_f32 v56, v56, v12
    v_fmac_f32 v56, v40, v13
    v_mul_f32 v57, v57, v12
    v_fmac_f32 v57, v41, v13
    v_mul_f32 v58, v58, v12
    v_fmac_f32 v58, v42, v13
    v_mul_f32 v59, v59, v12
    v_fmac_f32 v59, v43, v13
    v_mul_f32 v60, v60, v12
    v_fmac_f32 v60, v44, v13
    v_mul_f32 v61, v61, v12
    v_fmac_f32 v61, v45, v13
    v_mul_f32 v62, v62, v12
    v_fmac_f32 v62, v46, v13
    v_mul_f32 v63, v63, v12
    v_fmac_f32 v63, v47, v13
    v_mul_f32 v64, v64, v12
    v_fmac_f32 v64, v48, v13
    v_mul_f32 v65, v65, v12
    v_fmac_f32 v65, v49, v13
    v_cvt_pk_bf16_f32 v32, v56, v57
    v_cvt_pk_bf16_f32 v33, v58, v59
    v_cvt_pk_bf16_f32 v34, v60, v61
    v_cvt_pk_bf16_f32 v35, v62, v63
    v_cvt_pk_bf16_f32 v36, v64, v65
    buffer_store_dwordx4 v[32:35], v8, s[12:15], s34 offen sc1
    s_mov_b32 exec_hi, 0
    buffer_store_dword v36, v8, s[12:15], s35 offen sc1
    s_mov_b32 exec_hi, -1
    s_mov_b64 exec, 1
    ds_add_u32 v160, v161 offset:44
    s_mov_b64 exec, -1
    s_mov_b32 s93, 0
    s_branch L_cwe_105
L_cw_103:
    s_sleep 1
L_cwe_105:
    ds_read_b32 v15, v160 offset:40
    s_add_u32 s93, s93, 1
    s_waitcnt lgkmcnt(0)
    v_readfirstlane_b32 s100, v15
    s_cmp_ge_u32 s93, 1280000
    s_cbranch_scc1 L_cwd_104
    s_cmp_lt_u32 s100, 4
    s_cbranch_scc1 L_cw_103
L_cwd_104:
    s_and_b32 s96, s24, 3
    v_lshrrev_b32 v11, 5, v1
    v_bfe_u32 v12, v1, 4, 1
    v_bfe_u32 v13, v1, 2, 2
    v_and_b32 v14, 3, v1
    v_lshl_add_u32 v15, v12, 2, v14
    v_mul_u32_u24 v12, 1152, v11
    v_lshl_add_u32 v12, v13, 6, v12
    v_lshl_add_u32 v22, v15, 3, v12
    s_lshr_b32 s29, s96, 1
    s_lshl_b32 s29, s29, 8
    s_add_u32 s29, s29, 77824
    v_add_u32 v22, s29, v22
    s_mul_i32 s29, s36, 41472
    v_add_u32 v22, s29, v22
    ds_read_b64_tr_b16 v[72:73], v22 offset:0
    ds_read_b64_tr_b16 v[74:75], v22 offset:576
    ds_read_b64_tr_b16 v[76:77], v22 offset:2304
    ds_read_b64_tr_b16 v[78:79], v22 offset:2880
    ds_read_b64_tr_b16 v[80:81], v22 offset:4608
    ds_read_b64_tr_b16 v[82:83], v22 offset:5184
    ds_read_b64_tr_b16 v[84:85], v22 offset:6912
    ds_read_b64_tr_b16 v[86:87], v22 offset:7488
    ds_read_b64_tr_b16 v[88:89], v22 offset:9216
    ds_read_b64_tr_b16 v[90:91], v22 offset:9792
    ds_read_b64_tr_b16 v[92:93], v22 offset:11520
    ds_read_b64_tr_b16 v[94:95], v22 offset:12096
    s_waitcnt lgkmcnt(2)
    ds_read_b64_tr_b16 v[96:97], v22 offset:13824
    ds_read_b64_tr_b16 v[98:99], v22 offset:14400
    ds_read_b64_tr_b16 v[100:101], v22 offset:16128
    ds_read_b64_tr_b16 v[102:103], v22 offset:16704
    ds_read_b64_tr_b16 v[104:105], v22 offset:18432
    ds_read_b64_tr_b16 v[106:107], v22 offset:19008
    ds_read_b64_tr_b16 v[108:109], v22 offset:20736
    ds_read_b64_tr_b16 v[110:111], v22 offset:21312
    ds_read_b64_tr_b16 v[112:113], v22 offset:23040
    ds_read_b64_tr_b16 v[114:115], v22 offset:23616
    ds_read_b64_tr_b16 v[116:117], v22 offset:25344
    ds_read_b64_tr_b16 v[118:119], v22 offset:25920
    s_waitcnt lgkmcnt(2)
    ds_read_b64_tr_b16 v[120:121], v22 offset:27648
    ds_read_b64_tr_b16 v[122:123], v22 offset:28224
    ds_read_b64_tr_b16 v[124:125], v22 offset:29952
    ds_read_b64_tr_b16 v[126:127], v22 offset:30528
    ds_read_b64_tr_b16 v[128:129], v22 offset:32256
    ds_read_b64_tr_b16 v[130:131], v22 offset:32832
    ds_read_b64_tr_b16 v[132:133], v22 offset:34560
    ds_read_b64_tr_b16 v[134:135], v22 offset:35136
    ds_read_b64_tr_b16 v[136:137], v22 offset:36864
    ds_read_b64_tr_b16 v[138:139], v22 offset:37440
    ds_read_b64_tr_b16 v[140:141], v22 offset:39168
    ds_read_b64_tr_b16 v[142:143], v22 offset:39744
    s_waitcnt lgkmcnt(2)
    s_mul_i32 s74, s25, 73728
    s_add_u32 s74, s74, s75
    s_lshl_b32 s29, s25, 8
    s_add_u32 s29, s29, 7340032
    v_lshlrev_b32 v11, 2, v164
    buffer_load_dword v165, v11, s[12:15], s29 offen sc1
    s_mov_b32 s94, 0
    s_and_b32 s29, s24, 1
    s_mul_i32 s29, s29, 36864
    s_mul_i32 s32, s36, 18432
    s_add_u32 s29, s29, s32
    s_add_u32 s29, s29, 77824
    v_add_u32 v23, s29, v8
    s_waitcnt lgkmcnt(0)
    s_mov_b64 exec, 1
    ds_add_u32 v160, v161 offset:8
    s_mov_b64 exec, -1
L_try_a:
    v_mov_b32 v40, 0
    v_mov_b32 v41, 0
    v_mov_b32 v42, 0
    v_mov_b32 v43, 0
    v_mov_b32 v44, 0
    v_mov_b32 v45, 0
    v_mov_b32 v46, 0
    v_mov_b32 v47, 0
    v_mov_b32 v48, 0
    v_mov_b32 v49, 0
    v_mov_b32 v50, 0
    v_mov_b32 v51, 0
    v_mov_b32 v52, 0
    v_mov_b32 v53, 0
    v_mov_b32 v54, 0
    v_mov_b32 v55, 0
    v_mov_b32 v153, 0
    s_mov_b32 s93, 0
    s_branch L_cwe_108
L_cw_106:
    s_sleep 1
L_cwe_108:
    ds_read_b32 v15, v160 offset:8
    s_add_u32 s93, s93, 1
    s_waitcnt lgkmcnt(0)
    v_readfirstlane_b32 s100, v15
    s_cmp_ge_u32 s93, 1280000
    s_cbranch_scc1 L_cwd_107
    s_cmp_lt_u32 s100, 12
    s_cbranch_scc1 L_cw_106
L_cwd_107:
    s_lshr_b32 s29, s24, 2
    s_mul_i32 s95, s29, 36864
    s_and_b32 s29, s24, 3
    s_lshl_b32 s29, s29, 10
    s_add_u32 s95, s95, s29
    s_mul_i32 s96, s25, 73728
    s_add_u32 s96, s96, 2621440
    s_add_u32 s96, s96, s95
    s_add_u32 s95, s95, 77824
    s_mov_b32 s92, 0
    s_mov_b32 s93, 0
L_of_109:
    ds_read_b32 v15, v160 offset:12
    s_add_u32 s93, s93, 1
    s_waitcnt lgkmcnt(0)
    v_readfirstlane_b32 s100, v15
    s_cmp_ge_u32 s93, 1280000
    s_cselect_b32 s100, 0xff, s100
    s_cmp_eq_u32 s100, 0xff
    s_cselect_b32 s100, 0x1ff, s100
    s_andn2_b32 s100, s100, s92
    s_or_b32 s92, s92, s100
L_ofb_110:
    s_cmp_eq_u32 s100, 0
    s_cbranch_scc1 L_ofn_111
    s_ff1_i32_b32 s29, s100
    s_bitset0_b32 s100, s29
    s_lshl_b32 s29, s29, 12
    s_add_u32 s32, s29, s95
    s_mov_b32 m0, s32
    s_add_u32 s32, s29, s96
    buffer_load_dwordx4 v8, s[12:15], s32 offen sc1 lds
    s_branch L_ofb_110
L_ofn_111:
    s_cmp_eq_u32 s92, 0x1ff
    s_cbranch_scc1 L_ofx_112
    s_sleep 1
    s_branch L_of_109
L_ofx_112:
    v_lshrrev_b32 v11, 5, v1
    s_bfe_u32 s33, s24, 0x10001
    s_lshl_b32 s33, s33, 5
    s_lshl_b32 s29, s36, 4
    s_add_u32 s33, s33, s29
    v_mul_u32_u24 v152, 144, v164
    v_lshl_add_u32 v152, v11, 3, v152
    s_lshl_b32 s29, s33, 1
    s_add_u32 s29, s29, 0
    v_add_u32 v152, s29, v152
    v_bfe_u32 v13, v1, 2, 2
    v_lshl_add_u32 v13, v11, 2, v13
    v_lshlrev_b32 v13, 7, v13
    v_and_b32 v14, 48, v164
    v_lshl_add_u32 v13, v14, 1, v13
    v_and_b32 v14, 3, v1
    v_lshl_add_u32 v13, v14, 3, v13
    s_lshl_b32 s29, s33, 7
    s_add_u32 s29, s29, 9216
    v_add_u32 v13, s29, v13
    ds_read_b64 v[32:33], v152 offset:0
    ds_read_b64_tr_b16 v[34:35], v13 offset:0
    ds_read_b64 v[36:37], v152 offset:16
    ds_read_b64_tr_b16 v[38:39], v13 offset:1024
    s_mov_b32 s95, 0xffff0000
    s_waitcnt vmcnt(9) lgkmcnt(0)
    v_sub_f32 v15, 1.0, v165
    v_cvt_pk_bf16_f32 v15, v15, v15
    v_and_b32 v15, 0xffff0000, v15
    v_lshlrev_b32 v24, 16, v32
    v_and_b32 v25, s95, v32
    v_lshlrev_b32 v28, 16, v34
    v_and_b32 v29, s95, v34
    v_lshlrev_b32 v26, 16, v33
    v_and_b32 v27, s95, v33
    v_lshlrev_b32 v30, 16, v35
    v_and_b32 v31, s95, v35
    v_mul_f32 v24, v24, v28
    v_mul_f32 v144, v15, v24
    v_mul_f32 v25, v25, v29
    v_mul_f32 v145, v15, v25
    v_mul_f32 v26, v26, v30
    v_mul_f32 v146, v15, v26
    v_mul_f32 v27, v27, v31
    v_mul_f32 v147, v15, v27
    v_lshlrev_b32 v24, 16, v36
    v_and_b32 v25, s95, v36
    v_lshlrev_b32 v28, 16, v38
    v_and_b32 v29, s95, v38
    v_lshlrev_b32 v26, 16, v37
    v_and_b32 v27, s95, v37
    v_lshlrev_b32 v30, 16, v39
    v_and_b32 v31, s95, v39
    v_mul_f32 v24, v24, v28
    v_mul_f32 v148, v15, v24
    v_mul_f32 v25, v25, v29
    v_mul_f32 v149, v15, v25
    v_mul_f32 v26, v26, v30
    v_mul_f32 v150, v15, v26
    v_mul_f32 v27, v27, v31
    v_mul_f32 v151, v15, v27
    s_waitcnt vmcnt(0)
    s_barrier
    ds_read_b128 v[56:59], v23 offset:0
    ds_read_b128 v[60:63], v23 offset:1024
    ds_read_b128 v[64:67], v23 offset:2048
    ds_read_b128 v[68:71], v23 offset:3072
    s_waitcnt lgkmcnt(3)
    v_mfma_f32_32x32x16_bf16 v[40:55], v[72:75], v[56:59], v[40:55]
    v_max3_u32 v153, v153, v56, v57
    v_max3_u32 v153, v153, v58, v59
    ds_read_b128 v[56:59], v23 offset:4096
    s_waitcnt lgkmcnt(3)
    v_mfma_f32_32x32x16_bf16 v[40:55], v[76:79], v[60:63], v[40:55]
    v_max3_u32 v153, v153, v60, v61
    v_max3_u32 v153, v153, v62, v63
    ds_read_b128 v[60:63], v23 offset:5120
    s_waitcnt lgkmcnt(3)
    v_mfma_f32_32x32x16_bf16 v[40:55], v[80:83], v[64:67], v[40:55]
    v_max3_u32 v153, v153, v64, v65
    v_max3_u32 v153, v153, v66, v67
    ds_read_b128 v[64:67], v23 offset:6144
    s_waitcnt lgkmcnt(3)
    v_mfma_f32_32x32x16_bf16 v[40:55], v[84:87], v[68:71], v[40:55]
    v_max3_u32 v153, v153, v68, v69
    v_max3_u32 v153, v153, v70, v71
    ds_read_b128 v[68:71], v23 offset:7168
    s_waitcnt lgkmcnt(3)
    v_mfma_f32_32x32x16_bf16 v[40:55], v[88:91], v[56:59], v[40:55]
    v_max3_u32 v153, v153, v56, v57
    v_max3_u32 v153, v153, v58, v59
    ds_read_b128 v[56:59], v23 offset:8192
    s_waitcnt lgkmcnt(3)
    v_mfma_f32_32x32x16_bf16 v[40:55], v[92:95], v[60:63], v[40:55]
    v_max3_u32 v153, v153, v60, v61
    v_max3_u32 v153, v153, v62, v63
    ds_read_b128 v[60:63], v23 offset:9216
    s_waitcnt lgkmcnt(3)
    v_mfma_f32_32x32x16_bf16 v[40:55], v[96:99], v[64:67], v[40:55]
    v_max3_u32 v153, v153, v64, v65
    v_max3_u32 v153, v153, v66, v67
    ds_read_b128 v[64:67], v23 offset:10240
    s_waitcnt lgkmcnt(3)
    v_mfma_f32_32x32x16_bf16 v[40:55], v[100:103], v[68:71], v[40:55]
    v_max3_u32 v153, v153, v68, v69
    v_max3_u32 v153, v153, v70, v71
    ds_read_b128 v[68:71], v23 offset:11264
    s_waitcnt lgkmcnt(3)
    v_mfma_f32_32x32x16_bf16 v[40:55], v[104:107], v[56:59], v[40:55]
    v_max3_u32 v153, v153, v56, v57
    v_max3_u32 v153, v153, v58, v59
    ds_read_b128 v[56:59], v23 offset:12288
    s_waitcnt lgkmcnt(3)
    v_mfma_f32_32x32x16_bf16 v[40:55], v[108:111], v[60:63], v[40:55]
    v_max3_u32 v153, v153, v60, v61
    v_max3_u32 v153, v153, v62, v63
    ds_read_b128 v[60:63], v23 offset:13312
    s_waitcnt lgkmcnt(3)
    v_mfma_f32_32x32x16_bf16 v[40:55], v[112:115], v[64:67], v[40:55]
    v_max3_u32 v153, v153, v64, v65
    v_max3_u32 v153, v153, v66, v67
    ds_read_b128 v[64:67], v23 offset:14336
    s_waitcnt lgkmcnt(3)
    v_mfma_f32_32x32x16_bf16 v[40:55], v[116:119], v[68:71], v[40:55]
    v_max3_u32 v153, v153, v68, v69
    v_max3_u32 v153, v153, v70, v71
    ds_read_b128 v[68:71], v23 offset:15360
    s_waitcnt lgkmcnt(3)
    v_mfma_f32_32x32x16_bf16 v[40:55], v[120:123], v[56:59], v[40:55]
    v_max3_u32 v153, v153, v56, v57
    v_max3_u32 v153, v153, v58, v59
    ds_read_b128 v[56:59], v23 offset:16384
    s_waitcnt lgkmcnt(3)
    v_mfma_f32_32x32x16_bf16 v[40:55], v[124:127], v[60:63], v[40:55]
    v_max3_u32 v153, v153, v60, v61
    v_max3_u32 v153, v153, v62, v63
    ds_read_b128 v[60:63], v23 offset:17408
    s_waitcnt lgkmcnt(3)
    v_mfma_f32_32x32x16_bf16 v[40:55], v[128:131], v[64:67], v[40:55]
    v_max3_u32 v153, v153, v64, v65
    v_max3_u32 v153, v153, v66, v67
    s_waitcnt lgkmcnt(2)
    v_mfma_f32_32x32x16_bf16 v[40:55], v[132:135], v[68:71], v[40:55]
    v_max3_u32 v153, v153, v68, v69
    v_max3_u32 v153, v153, v70, v71
    s_waitcnt lgkmcnt(1)
    v_mfma_f32_32x32x16_bf16 v[40:55], v[136:139], v[56:59], v[40:55]
    v_max3_u32 v153, v153, v56, v57
    v_max3_u32 v153, v153, v58, v59
    s_waitcnt lgkmcnt(0)
    v_mfma_f32_32x32x16_bf16 v[40:55], v[140:143], v[60:63], v[40:55]
    v_max3_u32 v153, v153, v60, v61
    v_max3_u32 v153, v153, v62, v63
    s_lshl_b32 s29, s24, 11
    s_add_u32 s29, s29, 38912
    v_add_u32 v11, s29, v8
    s_lshl_b32 s29, s24, 11
    s_xor_b32 s29, s29, 8192
    s_add_u32 s29, s29, 38912
    v_add_u32 v12, s29, v8
    s_nop 5
L_rk0:
    s_cmp_eq_u32 s36, 1
    s_cbranch_scc1 L_rk1
    ds_write_b128 v11, v[48:51]
    ds_write_b128 v11, v[52:55] offset:1024
    v_fmac_f32 v144, v165, v40
    v_fmac_f32 v145, v165, v41
    v_fmac_f32 v146, v165, v42
    v_fmac_f32 v147, v165, v43
    v_fmac_f32 v148, v165, v44
    v_fmac_f32 v149, v165, v45
    v_fmac_f32 v150, v165, v46
    v_fmac_f32 v151, v165, v47
    s_branch L_rkj
L_rk1:
    ds_write_b128 v11, v[40:43]
    ds_write_b128 v11, v[44:47] offset:1024
    v_fmac_f32 v144, v165, v48
    v_fmac_f32 v145, v165, v49
    v_fmac_f32 v146, v165, v50
    v_fmac_f32 v147, v165, v51
    v_fmac_f32 v148, v165, v52
    v_fmac_f32 v149, v165, v53
    v_fmac_f32 v150, v165, v54
    v_fmac_f32 v151, v165, v55
L_rkj:
    s_lshl_b32 s29, s94, 2
    v_add_u32 v14, s29, v160
    v_cmp_eq_u32 vcc, -1, v153
    s_nop 4
    s_cbranch_vccz L_nb_113
    s_mov_b64 exec, 1
    ds_add_u32 v14, v161 offset:128
    s_mov_b64 exec, -1
L_nb_113:
    s_waitcnt lgkmcnt(0)
    s_barrier
    ds_read_b32 v15, v14 offset:128
    ds_read_b128 v[56:59], v12
    ds_read_b128 v[60:63], v12 offset:1024
    s_waitcnt lgkmcnt(0)
    v_readfirstlane_b32 s100, v15
    s_cmp_eq_u32 s100, 0
    s_cbranch_scc1 L_tok_114
    s_add_u32 s94, s94, 1
    s_cmp_ge_u32 s94, 16
    s_cbranch_scc1 L_tok_114
    s_sleep 8
    s_barrier
    s_branch L_try_a
L_tok_114:
    v_fmac_f32 v144, v165, v56
    v_fmac_f32 v145, v165, v57
    v_fmac_f32 v146, v165, v58
    v_fmac_f32 v147, v165, v59
    v_cvt_pk_bf16_f32 v32, v144, v145
    v_cvt_pk_bf16_f32 v33, v146, v147
    ds_write_b64 v152, v[32:33] offset:0
    v_fmac_f32 v148, v165, v60
    v_fmac_f32 v149, v165, v61
    v_fmac_f32 v150, v165, v62
    v_fmac_f32 v151, v165, v63
    v_cvt_pk_bf16_f32 v34, v148, v149
    v_cvt_pk_bf16_f32 v35, v150, v151
    ds_write_b64 v152, v[34:35] offset:16
    s_branch L_store
L_helper:
    s_setprio 3
    s_load_dwordx2 s[6:7], s[40:41], 0
    s_waitcnt lgkmcnt(0)
    v_mov_b32 v162, s6
    v_mov_b32 v163, s7
    s_mov_b32 s93, 0
    v_mov_b32 v15, 0
L_tg_115:
    v_cmp_eq_u32 vcc, 0, v162
    s_nop 4
    s_cbranch_vccz L_tgd_116
    s_add_u32 s93, s93, 1
    s_cmp_ge_u32 s93, 20000
    s_cbranch_scc1 L_tgd_116
    s_sleep 4
    global_load_dwordx2 v[162:163], v15, s[40:41] sc1
    s_waitcnt vmcnt(0)
    s_branch L_tg_115
L_tgd_116:
    v_mov_b32 v128, 0
    s_mov_b32 s93, 0
    s_branch L_cwe_119
L_cw_117:
    s_sleep 2
L_cwe_119:
    ds_read_b32 v15, v160 offset:24
    s_add_u32 s93, s93, 1
    s_waitcnt lgkmcnt(0)
    v_readfirstlane_b32 s100, v15
    s_cmp_ge_u32 s93, 1280000
    s_cbranch_scc1 L_cwd_118
    s_cmp_lt_u32 s100, 8
    s_cbranch_scc1 L_cw_117
L_cwd_118:
    s_cmp_lg_u32 s23, 0
    s_cbranch_scc1 L_ho_120
    s_mov_b32 s101, 2
    s_add_u32 s95, s101, s72
    s_and_b32 s95, s95, 7
    s_lshl_b32 s95, s95, 11
    s_add_u32 s95, s95, 262144
    v_and_b32 v11, 31, v1
    v_lshlrev_b32 v11, 6, v11
    s_mov_b32 s93, 0
L_pf_121:
    buffer_load_dwordx2 v[152:153], v11, s[12:15], s95 offen offset:0 sc1
    s_add_u32 s93, s93, 1
    s_waitcnt vmcnt(0)
    v_cmp_ne_u64 vcc, v[152:153], v[162:163]
    s_nop 4
    s_cbranch_vccz L_pfd_122
    s_sleep 20
    s_cmp_lt_u32 s93, 20000
    s_cbranch_scc1 L_pf_121
L_pfd_122:
    s_mov_b32 s93, 0
    s_branch L_cwe_125
L_cw_123:
    s_sleep 2
L_cwe_125:
    ds_read_b32 v15, v160 offset:24
    s_add_u32 s93, s93, 1
    s_waitcnt lgkmcnt(0)
    v_readfirstlane_b32 s100, v15
    s_cmp_ge_u32 s93, 1280000
    s_cbranch_scc1 L_cwd_124
    s_cmp_lt_u32 s100, 8
    s_cbranch_scc1 L_cw_123
L_cwd_124:
    s_mov_b32 s101, 2
    s_mov_b32 s33, 0
    s_add_u32 s95, s101, s72
    s_and_b32 s95, s95, 7
    s_mul_i32 s95, s95, 19456
    s_add_u32 s95, s95, 0
    s_and_b32 s96, s101, 3
    s_mul_i32 s96, s96, 19456
    s_lshl_b32 s39, s33, 10
L_p0_126:
    s_add_u32 s32, s39, s96
    s_mov_b32 m0, s32
    s_add_u32 s32, s39, s95
    buffer_load_dwordx4 v8, s[12:15], s32 offen sc1 lds
    s_add_u32 s39, s39, 1024
    s_cmp_lt_u32 s39, 19456
    s_cbranch_scc1 L_p0_126
L_ho_120:
    s_lshl_b32 s96, s26, 2
    s_add_u32 s96, s96, s23
    s_lshl_b32 s96, s96, 4
    s_mul_i32 s39, s23, 16512
    s_add_u32 s39, s39, 77824
    s_mul_i32 s32, s25, 73728
    s_lshl_b32 s33, s96, 1
    s_add_u32 s32, s32, s33
    v_lshrrev_b32 v11, 1, v1
    v_mul_u32_u24 v11, 1152, v11
    v_and_b32 v12, 1, v1
    v_lshl_add_u32 v11, v12, 4, v11
    s_sub_u32 s33, s32, 3456
    v_add_u32 v12, s33, v11
    s_mov_b32 s16, s64
    s_and_b32 s17, s65, 0xffff
    s_mov_b32 s18, 2359296
    s_mov_b32 s19, 0x00020000
    s_mov_b32 s95, 0
    s_mov_b32 m0, s39
    s_nop 0
    buffer_load_dwordx4 v12, s[16:19], s95 offen lds
    s_add_u32 s95, s32, 33408
    s_add_u32 s29, s39, 1024
    s_mov_b32 m0, s29
    s_nop 0
    buffer_load_dwordx4 v11, s[16:19], s95 offen lds
    s_add_u32 s95, s32, 70272
    s_mov_b64 exec, 0x3f
    s_add_u32 s29, s39, 2048
    s_mov_b32 m0, s29
    s_nop 0
    buffer_load_dwordx4 v11, s[16:19], s95 offen lds
    s_mov_b64 exec, -1
    s_mov_b32 s16, s66
    s_and_b32 s17, s67, 0xffff
    s_mov_b32 s18, 2359296
    s_mov_b32 s19, 0x00020000
    s_add_u32 s95, s32, 0
    s_add_u32 s29, s39, 4096
    s_mov_b32 m0, s29
    s_nop 0
    buffer_load_dwordx4 v11, s[16:19], s95 offen lds
    s_add_u32 s95, s32, 36864
    s_add_u32 s29, s39, 5120
    s_mov_b32 m0, s29
    s_nop 0
    buffer_load_dwordx4 v11, s[16:19], s95 offen lds
    v_lshrrev_b32 v12, 3, v1
    v_lshl_add_u32 v12, v12, 1, s96
    v_lshlrev_b32 v13, 3, v12
    s_mov_b32 s16, s68
    s_and_b32 s17, s69, 0xffff
    s_mov_b32 s18, 4608
    s_mov_b32 s19, 0x00020000
    buffer_load_dwordx4 v[36:39], v13, s[16:19], 0 offen
    v_mul_u32_u24 v68, 4112, v12
    v_and_b32 v11, 7, v1
    v_lshlrev_b32 v11, 4, v11
    v_sub_u32 v68, v68, v11
    s_lshl_b32 s29, s25, 7
    s_sub_u32 s29, 7356400, s29
    v_add_u32 v68, s29, v68
    s_cmp_lg_u32 s23, 3
    s_cbranch_scc1 L_ho_127
    s_lshl_b32 s96, s26, 3
    s_add_u32 s96, s96, 512
    s_mul_i32 s39, s23, 16512
    s_add_u32 s39, s39, 86016
    s_mul_i32 s32, s25, 73728
    s_lshl_b32 s33, s96, 1
    s_add_u32 s32, s32, s33
    v_lshrrev_b32 v11, 0, v1
    v_mul_u32_u24 v11, 1152, v11
    s_sub_u32 s33, s32, 3456
    v_add_u32 v12, s33, v11
    s_mov_b32 s16, s64
    s_and_b32 s17, s65, 0xffff
    s_mov_b32 s18, 2359296
    s_mov_b32 s19, 0x00020000
    s_mov_b32 s95, 0
    s_mov_b32 m0, s39
    s_nop 0
    buffer_load_dwordx4 v12, s[16:19], s95 offen lds
    s_add_u32 s95, s32, 70272
    s_mov_b64 exec, 0x3f
    s_add_u32 s29, s39, 1024
    s_mov_b32 m0, s29
    s_nop 0
    buffer_load_dwordx4 v11, s[16:19], s95 offen lds
    s_mov_b64 exec, -1
    s_mov_b32 s16, s66
    s_and_b32 s17, s67, 0xffff
    s_mov_b32 s18, 2359296
    s_mov_b32 s19, 0x00020000
    s_add_u32 s95, s32, 0
    s_add_u32 s29, s39, 4096
    s_mov_b32 m0, s29
    s_nop 0
    buffer_load_dwordx4 v11, s[16:19], s95 offen lds
    v_lshrrev_b32 v12, 3, v1
    v_and_b32 v12, 3, v12
    v_lshl_add_u32 v12, v12, 1, s96
    v_lshlrev_b32 v13, 3, v12
    s_mov_b32 s16, s68
    s_and_b32 s17, s69, 0xffff
    s_mov_b32 s18, 4608
    s_mov_b32 s19, 0x00020000
    buffer_load_dwordx4 v[96:99], v13, s[16:19], 0 offen
    v_mul_u32_u24 v128, 4112, v12
    v_and_b32 v11, 7, v1
    v_lshlrev_b32 v11, 4, v11
    v_sub_u32 v128, v128, v11
    s_lshl_b32 s29, s25, 7
    s_sub_u32 s29, 7356400, s29
    v_add_u32 v128, s29, v128
L_ho_127:
    s_waitcnt vmcnt(0)
    s_cmp_lg_u32 s23, 0
    s_cbranch_scc1 L_ho_128
    s_mov_b64 exec, 1
    ds_add_u32 v160, v161 offset:116
    s_mov_b64 exec, -1
L_ho_128:
    s_cmp_lg_u32 s23, 2
    s_cbranch_scc1 L_ho_129
    s_mov_b32 s95, 262144
    v_lshlrev_b32 v11, 8, v1
    s_mov_b32 s93, 0
L_pf_130:
    buffer_load_dwordx2 v[152:153], v11, s[12:15], s95 offen offset:0 sc1
    buffer_load_dwordx2 v[154:155], v11, s[12:15], s95 offen offset:64 sc1
    buffer_load_dwordx2 v[156:157], v11, s[12:15], s95 offen offset:128 sc1
    buffer_load_dwordx2 v[158:159], v11, s[12:15], s95 offen offset:192 sc1
    s_add_u32 s93, s93, 1
    s_waitcnt vmcnt(0)
    v_cmp_ne_u64 vcc, v[152:153], v[162:163]
    v_cmp_ne_u64 s[98:99], v[154:155], v[162:163]
    s_nop 4
    s_or_b64 vcc, vcc, s[98:99]
    v_cmp_ne_u64 s[98:99], v[156:157], v[162:163]
    s_nop 4
    s_or_b64 vcc, vcc, s[98:99]
    v_cmp_ne_u64 s[98:99], v[158:159], v[162:163]
    s_nop 4
    s_or_b64 vcc, vcc, s[98:99]
    s_nop 4
    s_cbranch_vccz L_pfd_131
    s_sleep 20
    s_cmp_lt_u32 s93, 20000
    s_cbranch_scc1 L_pf_130
L_pfd_131:
    s_mov_b64 exec, 1
    ds_add_u32 v160, v161 offset:116
    s_mov_b64 exec, -1
    s_mov_b32 s101, 3
    s_mov_b32 s33, 0
    s_add_u32 s95, s101, s72
    s_and_b32 s95, s95, 7
    s_mul_i32 s95, s95, 19456
    s_add_u32 s95, s95, 0
    s_and_b32 s96, s101, 3
    s_mul_i32 s96, s96, 19456
    s_lshl_b32 s39, s33, 10
L_p0_132:
    s_add_u32 s32, s39, s96
    s_mov_b32 m0, s32
    s_add_u32 s32, s39, s95
    buffer_load_dwordx4 v8, s[12:15], s32 offen sc1 lds
    s_add_u32 s39, s39, 1024
    s_cmp_lt_u32 s39, 19456
    s_cbranch_scc1 L_p0_132
L_ho_129:
    s_mul_i32 s39, s23, 16512
    s_add_u32 s39, s39, 77824
    v_and_b32 v11, 7, v1
    v_mul_u32_u24 v11, 256, v11
    v_lshrrev_b32 v12, 3, v1
    v_lshl_add_u32 v11, v12, 2, v11
    v_add_u32 v11, s39, v11
    ds_read2_b32 v[16:17], v11 offset0:0 offset1:8
    ds_read2_b32 v[18:19], v11 offset0:16 offset1:24
    ds_read2_b32 v[20:21], v11 offset0:32 offset1:40
    ds_read2_b32 v[22:23], v11 offset0:48 offset1:56
    ds_read2_b32 v[24:25], v11 offset0:64 offset1:72
    ds_read_b32 v26, v11 offset:320
    v_add_u32 v11, 4096, v11
    ds_read2_b32 v[28:29], v11 offset0:0 offset1:8
    ds_read2_b32 v[30:31], v11 offset0:16 offset1:24
    ds_read2_b32 v[32:33], v11 offset0:32 offset1:40
    ds_read2_b32 v[34:35], v11 offset0:48 offset1:56
    s_mov_b32 s95, 0xffff0000
    v_lshlrev_b32 v48, 16, v36
    v_and_b32 v50, s95, v36
    v_lshlrev_b32 v52, 16, v37
    v_and_b32 v54, s95, v37
    v_lshlrev_b32 v49, 16, v38
    v_and_b32 v51, s95, v38
    v_lshlrev_b32 v53, 16, v39
    v_and_b32 v55, s95, v39
    s_waitcnt lgkmcnt(0)
    v_lshlrev_b32 v40, 16, v16
    v_and_b32 v41, s95, v16
    v_lshlrev_b32 v42, 16, v17
    v_and_b32 v43, s95, v17
    v_lshlrev_b32 v44, 16, v18
    v_and_b32 v45, s95, v18
    v_lshlrev_b32 v46, 16, v19
    v_and_b32 v47, s95, v19
    v_pk_mul_f32 v[56:57], v[46:47], v[48:49]
    v_pk_fma_f32 v[56:57], v[44:45], v[50:51], v[56:57]
    v_pk_fma_f32 v[56:57], v[42:43], v[52:53], v[56:57]
    v_pk_fma_f32 v[56:57], v[40:41], v[54:55], v[56:57]
    v_lshlrev_b32 v12, 16, v28
    v_and_b32 v13, s95, v28
    v_pk_mul_f32 v[56:57], v[56:57], v[12:13]
    v_lshlrev_b32 v40, 16, v20
    v_and_b32 v41, s95, v20
    v_pk_mul_f32 v[58:59], v[40:41], v[48:49]
    v_pk_fma_f32 v[58:59], v[46:47], v[50:51], v[58:59]
    v_pk_fma_f32 v[58:59], v[44:45], v[52:53], v[58:59]
    v_pk_fma_f32 v[58:59], v[42:43], v[54:55], v[58:59]
    v_lshlrev_b32 v12, 16, v29
    v_and_b32 v13, s95, v29
    v_pk_mul_f32 v[58:59], v[58:59], v[12:13]
    v_cvt_pk_bf16_f32 v63, v58, v56
    v_cvt_pk_bf16_f32 v67, v59, v57
    v_lshlrev_b32 v42, 16, v21
    v_and_b32 v43, s95, v21
    v_pk_mul_f32 v[56:57], v[42:43], v[48:49]
    v_pk_fma_f32 v[56:57], v[40:41], v[50:51], v[56:57]
    v_pk_fma_f32 v[56:57], v[46:47], v[52:53], v[56:57]
    v_pk_fma_f32 v[56:57], v[44:45], v[54:55], v[56:57]
    v_lshlrev_b32 v12, 16, v30
    v_and_b32 v13, s95, v30
    v_pk_mul_f32 v[56:57], v[56:57], v[12:13]
    v_lshlrev_b32 v44, 16, v22
    v_and_b32 v45, s95, v22
    v_pk_mul_f32 v[58:59], v[44:45], v[48:49]
    v_pk_fma_f32 v[58:59], v[42:43], v[50:51], v[58:59]
    v_pk_fma_f32 v[58:59], v[40:41], v[52:53], v[58:59]
    v_pk_fma_f32 v[58:59], v[46:47], v[54:55], v[58:59]
    v_lshlrev_b32 v12, 16, v31
    v_and_b32 v13, s95, v31
    v_pk_mul_f32 v[58:59], v[58:59], v[12:13]
    v_cvt_pk_bf16_f32 v62, v58, v56
    v_cvt_pk_bf16_f32 v66, v59, v57
    v_lshlrev_b32 v46, 16, v23
    v_and_b32 v47, s95, v23
    v_pk_mul_f32 v[56:57], v[46:47], v[48:49]
    v_pk_fma_f32 v[56:57], v[44:45], v[50:51], v[56:57]
    v_pk_fma_f32 v[56:57], v[42:43], v[52:53], v[56:57]
    v_pk_fma_f32 v[56:57], v[40:41], v[54:55], v[56:57]
    v_lshlrev_b32 v12, 16, v32
    v_and_b32 v13, s95, v32
    v_pk_mul_f32 v[56:57], v[56:57], v[12:13]
    v_lshlrev_b32 v40, 16, v24
    v_and_b32 v41, s95, v24
    v_pk_mul_f32 v[58:59], v[40:41], v[48:49]
    v_pk_fma_f32 v[58:59], v[46:47], v[50:51], v[58:59]
    v_pk_fma_f32 v[58:59], v[44:45], v[52:53], v[58:59]
    v_pk_fma_f32 v[58:59], v[42:43], v[54:55], v[58:59]
    v_lshlrev_b32 v12, 16, v33
    v_and_b32 v13, s95, v33
    v_pk_mul_f32 v[58:59], v[58:59], v[12:13]
    v_cvt_pk_bf16_f32 v61, v58, v56
    v_cvt_pk_bf16_f32 v65, v59, v57
    v_lshlrev_b32 v42, 16, v25
    v_and_b32 v43, s95, v25
    v_pk_mul_f32 v[56:57], v[42:43], v[48:49]
    v_pk_fma_f32 v[56:57], v[40:41], v[50:51], v[56:57]
    v_pk_fma_f32 v[56:57], v[46:47], v[52:53], v[56:57]
    v_pk_fma_f32 v[56:57], v[44:45], v[54:55], v[56:57]
    v_lshlrev_b32 v12, 16, v34
    v_and_b32 v13, s95, v34
    v_pk_mul_f32 v[56:57], v[56:57], v[12:13]
    v_lshlrev_b32 v44, 16, v26
    v_and_b32 v45, s95, v26
    v_pk_mul_f32 v[58:59], v[44:45], v[48:49]
    v_pk_fma_f32 v[58:59], v[42:43], v[50:51], v[58:59]
    v_pk_fma_f32 v[58:59], v[40:41], v[52:53], v[58:59]
    v_pk_fma_f32 v[58:59], v[46:47], v[54:55], v[58:59]
    v_lshlrev_b32 v12, 16, v35
    v_and_b32 v13, s95, v35
    v_pk_mul_f32 v[58:59], v[58:59], v[12:13]
    v_cvt_pk_bf16_f32 v60, v58, v56
    v_cvt_pk_bf16_f32 v64, v59, v57
    s_mov_b32 s29, 4112
    buffer_store_dwordx4 v[60:63], v68, s[12:15], 0 offen sc1
    buffer_store_dwordx4 v[64:67], v68, s[12:15], s29 offen sc1
    s_cmp_lg_u32 s25, 0
    s_cbranch_scc1 L_nopad_133
    s_and_b32 exec_lo, exec_lo, 0x01010101
    s_and_b32 exec_hi, exec_hi, 0x01010101
    v_mov_b32 v72, 0
    v_mov_b32 v73, 0
    v_mov_b32 v74, 0
    v_mov_b32 v75, 0
    buffer_store_dwordx4 v[72:75], v68, s[12:15], 0 offen offset:16 sc1
    buffer_store_dwordx4 v[72:75], v68, s[12:15], s29 offen offset:16 sc1
L_nopad_133:
    s_mov_b64 exec, -1
    s_cmp_lg_u32 s23, 3
    s_cbranch_scc1 L_ho_134
    s_mul_i32 s39, s23, 16512
    s_add_u32 s39, s39, 86016
    v_and_b32 v11, 7, v1
    v_mul_u32_u24 v11, 128, v11
    v_lshrrev_b32 v12, 3, v1
    v_and_b32 v12, 3, v12
    v_lshl_add_u32 v11, v12, 2, v11
    v_add_u32 v11, s39, v11
    ds_read2_b32 v[16:17], v11 offset0:0 offset1:4
    ds_read2_b32 v[18:19], v11 offset0:8 offset1:12
    ds_read2_b32 v[20:21], v11 offset0:16 offset1:20
    ds_read2_b32 v[22:23], v11 offset0:24 offset1:28
    ds_read2_b32 v[24:25], v11 offset0:32 offset1:36
    ds_read_b32 v26, v11 offset:160
    v_add_u32 v11, 4096, v11
    ds_read2_b32 v[28:29], v11 offset0:0 offset1:4
    ds_read2_b32 v[30:31], v11 offset0:8 offset1:12
    ds_read2_b32 v[32:33], v11 offset0:16 offset1:20
    ds_read2_b32 v[34:35], v11 offset0:24 offset1:28
    s_mov_b32 s95, 0xffff0000
    v_lshlrev_b32 v48, 16, v96
    v_and_b32 v50, s95, v96
    v_lshlrev_b32 v52, 16, v97
    v_and_b32 v54, s95, v97
    v_lshlrev_b32 v49, 16, v98
    v_and_b32 v51, s95, v98
    v_lshlrev_b32 v53, 16, v99
    v_and_b32 v55, s95, v99
    s_waitcnt lgkmcnt(0)
    v_lshlrev_b32 v40, 16, v16
    v_and_b32 v41, s95, v16
    v_lshlrev_b32 v42, 16, v17
    v_and_b32 v43, s95, v17
    v_lshlrev_b32 v44, 16, v18
    v_and_b32 v45, s95, v18
    v_lshlrev_b32 v46, 16, v19
    v_and_b32 v47, s95, v19
    v_pk_mul_f32 v[56:57], v[46:47], v[48:49]
    v_pk_fma_f32 v[56:57], v[44:45], v[50:51], v[56:57]
    v_pk_fma_f32 v[56:57], v[42:43], v[52:53], v[56:57]
    v_pk_fma_f32 v[56:57], v[40:41], v[54:55], v[56:57]
    v_lshlrev_b32 v12, 16, v28
    v_and_b32 v13, s95, v28
    v_pk_mul_f32 v[56:57], v[56:57], v[12:13]
    v_lshlrev_b32 v40, 16, v20
    v_and_b32 v41, s95, v20
    v_pk_mul_f32 v[58:59], v[40:41], v[48:49]
    v_pk_fma_f32 v[58:59], v[46:47], v[50:51], v[58:59]
    v_pk_fma_f32 v[58:59], v[44:45], v[52:53], v[58:59]
    v_pk_fma_f32 v[58:59], v[42:43], v[54:55], v[58:59]
    v_lshlrev_b32 v12, 16, v29
    v_and_b32 v13, s95, v29
    v_pk_mul_f32 v[58:59], v[58:59], v[12:13]
    v_cvt_pk_bf16_f32 v123, v58, v56
    v_cvt_pk_bf16_f32 v127, v59, v57
    v_lshlrev_b32 v42, 16, v21
    v_and_b32 v43, s95, v21
    v_pk_mul_f32 v[56:57], v[42:43], v[48:49]
    v_pk_fma_f32 v[56:57], v[40:41], v[50:51], v[56:57]
    v_pk_fma_f32 v[56:57], v[46:47], v[52:53], v[56:57]
    v_pk_fma_f32 v[56:57], v[44:45], v[54:55], v[56:57]
    v_lshlrev_b32 v12, 16, v30
    v_and_b32 v13, s95, v30
    v_pk_mul_f32 v[56:57], v[56:57], v[12:13]
    v_lshlrev_b32 v44, 16, v22
    v_and_b32 v45, s95, v22
    v_pk_mul_f32 v[58:59], v[44:45], v[48:49]
    v_pk_fma_f32 v[58:59], v[42:43], v[50:51], v[58:59]
    v_pk_fma_f32 v[58:59], v[40:41], v[52:53], v[58:59]
    v_pk_fma_f32 v[58:59], v[46:47], v[54:55], v[58:59]
    v_lshlrev_b32 v12, 16, v31
    v_and_b32 v13, s95, v31
    v_pk_mul_f32 v[58:59], v[58:59], v[12:13]
    v_cvt_pk_bf16_f32 v122, v58, v56
    v_cvt_pk_bf16_f32 v126, v59, v57
    v_lshlrev_b32 v46, 16, v23
    v_and_b32 v47, s95, v23
    v_pk_mul_f32 v[56:57], v[46:47], v[48:49]
    v_pk_fma_f32 v[56:57], v[44:45], v[50:51], v[56:57]
    v_pk_fma_f32 v[56:57], v[42:43], v[52:53], v[56:57]
    v_pk_fma_f32 v[56:57], v[40:41], v[54:55], v[56:57]
    v_lshlrev_b32 v12, 16, v32
    v_and_b32 v13, s95, v32
    v_pk_mul_f32 v[56:57], v[56:57], v[12:13]
    v_lshlrev_b32 v40, 16, v24
    v_and_b32 v41, s95, v24
    v_pk_mul_f32 v[58:59], v[40:41], v[48:49]
    v_pk_fma_f32 v[58:59], v[46:47], v[50:51], v[58:59]
    v_pk_fma_f32 v[58:59], v[44:45], v[52:53], v[58:59]
    v_pk_fma_f32 v[58:59], v[42:43], v[54:55], v[58:59]
    v_lshlrev_b32 v12, 16, v33
    v_and_b32 v13, s95, v33
    v_pk_mul_f32 v[58:59], v[58:59], v[12:13]
    v_cvt_pk_bf16_f32 v121, v58, v56
    v_cvt_pk_bf16_f32 v125, v59, v57
    v_lshlrev_b32 v42, 16, v25
    v_and_b32 v43, s95, v25
    v_pk_mul_f32 v[56:57], v[42:43], v[48:49]
    v_pk_fma_f32 v[56:57], v[40:41], v[50:51], v[56:57]
    v_pk_fma_f32 v[56:57], v[46:47], v[52:53], v[56:57]
    v_pk_fma_f32 v[56:57], v[44:45], v[54:55], v[56:57]
    v_lshlrev_b32 v12, 16, v34
    v_and_b32 v13, s95, v34
    v_pk_mul_f32 v[56:57], v[56:57], v[12:13]
    v_lshlrev_b32 v44, 16, v26
    v_and_b32 v45, s95, v26
    v_pk_mul_f32 v[58:59], v[44:45], v[48:49]
    v_pk_fma_f32 v[58:59], v[42:43], v[50:51], v[58:59]
    v_pk_fma_f32 v[58:59], v[40:41], v[52:53], v[58:59]
    v_pk_fma_f32 v[58:59], v[46:47], v[54:55], v[58:59]
    v_lshlrev_b32 v12, 16, v35
    v_and_b32 v13, s95, v35
    v_pk_mul_f32 v[58:59], v[58:59], v[12:13]
    v_cvt_pk_bf16_f32 v120, v58, v56
    v_cvt_pk_bf16_f32 v124, v59, v57
    s_mov_b32 exec_hi, 0
    s_mov_b32 s29, 4112
    buffer_store_dwordx4 v[120:123], v128, s[12:15], 0 offen sc1
    buffer_store_dwordx4 v[124:127], v128, s[12:15], s29 offen sc1
    s_cmp_lg_u32 s25, 0
    s_cbranch_scc1 L_nopad_135
    s_and_b32 exec_lo, exec_lo, 0x01010101
    s_and_b32 exec_hi, exec_hi, 0x01010101
    v_mov_b32 v132, 0
    v_mov_b32 v133, 0
    v_mov_b32 v134, 0
    v_mov_b32 v135, 0
    buffer_store_dwordx4 v[132:135], v128, s[12:15], 0 offen offset:16 sc1
    buffer_store_dwordx4 v[132:135], v128, s[12:15], s29 offen offset:16 sc1
L_nopad_135:
    s_mov_b64 exec, -1
L_ho_134:
    s_waitcnt vmcnt(0)
    s_lshl_b32 s32, s26, 2
    s_add_u32 s32, s32, s23
    s_lshl_b32 s32, s32, 5
    s_add_u32 s32, s32, s25
    s_lshl_b32 s32, s32, 4
    s_add_u32 s32, s32, 204800
    s_mov_b64 exec, 3
    buffer_store_dwordx2 v[162:163], v9, s[12:15], s32 offen sc1
    s_mov_b64 exec, -1
    s_cmp_lg_u32 s23, 3
    s_cbranch_scc1 L_ho_136
    s_add_u32 s32, s26, 32
    s_lshl_b32 s29, s26, 2
    s_add_u32 s29, s29, 1
    s_cmp_eq_u32 s23, 3
    s_cselect_b32 s32, s32, s29
    s_lshl_b32 s32, s32, 5
    s_add_u32 s32, s32, s25
    s_lshl_b32 s32, s32, 4
    s_add_u32 s32, s32, 204800
    s_mov_b64 exec, 3
    buffer_store_dwordx2 v[162:163], v9, s[12:15], s32 offen sc1
    s_mov_b64 exec, -1
L_ho_136:
    s_cmp_lg_u32 s23, 2
    s_cbranch_scc1 L_ho_137
    s_mov_b64 exec, 1
    ds_add_u32 v160, v161 offset:120
    s_mov_b64 exec, -1
L_ho_137:
L_h_kvp_done:
    s_cmp_ge_u32 s23, 3
    s_cbranch_scc1 L_ww_138
    s_lshr_b32 s29, s2, 3
    s_mul_i32 s29, s29, 3
    s_add_u32 s29, s29, s23
    s_mul_i32 s29, s29, 6912
    buffer_load_dwordx4 v[72:75], v8, s[80:83], s29 offen
    s_add_u32 s29, s29, 1024
    buffer_load_dwordx4 v[76:79], v8, s[80:83], s29 offen
    s_add_u32 s29, s29, 1024
    buffer_load_dwordx4 v[80:83], v8, s[80:83], s29 offen
    s_add_u32 s29, s29, 1024
    buffer_load_dwordx4 v[84:87], v8, s[80:83], s29 offen
    s_add_u32 s29, s29, 1024
    buffer_load_dwordx4 v[88:91], v8, s[80:83], s29 offen
    s_add_u32 s29, s29, 1024
    buffer_load_dwordx4 v[92:95], v8, s[80:83], s29 offen
    s_add_u32 s29, s29, 1024
    buffer_load_dwordx4 v[96:99], v8, s[80:83], s29 offen
    s_add_u32 s29, s29, 1024
L_ww_138:
    s_mov_b32 s101, 1
    s_mov_b32 s28, 1
    s_min_u32 s3, s23, 2
    s_lshl_b32 s3, s3, 8
    s_add_u32 s3, s3, s2
    s_cmp_lt_u32 s23, 2
    s_cbranch_scc1 L_hj_139
    s_cmp_lt_u32 s2, 64
    s_cbranch_scc0 L_hb_140
    s_cmp_eq_u32 s23, 3
    s_cbranch_scc1 L_hj_139
    s_branch L_h_convdone
L_hb_140:
    s_mov_b32 s101, 0
    s_sub_u32 s3, s2, 64
    s_mul_i32 s3, s3, 3
    s_sub_u32 s28, s23, 1
    s_add_u32 s3, s3, s28
    s_sub_u32 s3, s3, 1
L_hj_139:
    s_mov_b32 s93, 0
    s_branch L_cwe_143
L_cw_141:
    s_sleep 8
L_cwe_143:
    ds_read_b32 v15, v160 offset:24
    s_add_u32 s93, s93, 1
    s_waitcnt lgkmcnt(0)
    v_readfirstlane_b32 s100, v15
    s_cmp_ge_u32 s93, 1280000
    s_cbranch_scc1 L_cwd_142
    s_cmp_lt_u32 s100, 24
    s_cbranch_scc1 L_cw_141
L_cwd_142:
    s_mul_i32 s39, s23, 16512
    s_add_u32 s39, s39, 77824
    s_mov_b32 s94, s28
L_h_prep:
    v_mov_b32 v106, v107
    s_lshr_b32 s95, s3, 4
    s_lshr_b32 s33, s3, 3
    s_sub_u32 s33, s33, 32
    s_cmp_lt_u32 s3, 512
    s_cselect_b32 s95, s95, s33
    s_lshl_b32 s95, s95, 9
    s_add_u32 s95, s95, 204800
    s_lshl_b32 s32, s3, 12
    s_add_u32 s32, s70, s32
    s_addc_u32 s33, s71, 0
    s_mov_b32 s16, s32
    s_and_b32 s17, s33, 0xffff
    s_mov_b32 s18, 4096
    s_mov_b32 s19, 0x00020000
    s_mov_b32 s33, 0
    v_subrev_u32 v11, 512, v8
    s_add_u32 s29, s39, 8320
    s_mov_b32 m0, s29
    s_nop 0
    buffer_load_dwordx4 v11, s[16:19], s33 offen lds
    s_mov_b32 s33, 512
    s_add_u32 s29, s39, 9344
    s_mov_b32 m0, s29
    s_nop 0
    buffer_load_dwordx4 v8, s[16:19], s33 offen lds
    s_mov_b32 s33, 1536
    s_add_u32 s29, s39, 10368
    s_mov_b32 m0, s29
    s_nop 0
    buffer_load_dwordx4 v8, s[16:19], s33 offen lds
    s_cmp_eq_u32 s101, 0
    s_cbranch_scc1 L_ch_144
    s_mov_b32 s33, 2560
    s_add_u32 s29, s39, 11392
    s_mov_b32 m0, s29
    s_nop 0
    buffer_load_dwordx4 v8, s[16:19], s33 offen lds
    s_mov_b32 s33, 3584
    s_add_u32 s29, s39, 12416
    s_mov_b32 m0, s29
    s_nop 0
    buffer_load_dwordx4 v8, s[16:19], s33 offen lds
L_ch_144:
    s_mov_b32 s16, s42
    s_and_b32 s17, s43, 0xffff
    s_mov_b32 s18, 1152
    s_mov_b32 s19, 0x00020000
    s_lshl_b32 s32, s3, 1
    v_mov_b32 v11, 0
    buffer_load_ushort v107, v11, s[16:19], s32 offen
    v_and_b32 v11, 31, v1
    v_lshlrev_b32 v11, 4, v11
    s_mov_b32 s93, 0
L_pf_145:
    buffer_load_dwordx2 v[152:153], v11, s[12:15], s95 offen offset:0 sc1
    s_add_u32 s93, s93, 1
    s_waitcnt vmcnt(0)
    v_cmp_ne_u64 vcc, v[152:153], v[162:163]
    s_nop 4
    s_cbranch_vccz L_pfd_146
    s_sleep 24
    s_cmp_lt_u32 s93, 20000
    s_cbranch_scc1 L_pf_145
L_pfd_146:
    s_mul_i32 s32, s3, 4112
    s_add_u32 s32, s32, 7352320
    s_add_u32 s32, s4, s32
    s_addc_u32 s33, s5, 0
    s_mov_b32 s16, s32
    s_and_b32 s17, s33, 0xffff
    s_mov_b32 s18, 4112
    s_mov_b32 s19, 0x00020000
    s_mov_b64 exec, 0xf
    s_mov_b32 s33, 4096
    s_add_u32 s29, s39, 4096
    s_mov_b32 m0, s29
    s_nop 0
    buffer_load_dwordx4 v8, s[16:19], s33 offen sc1 lds
    s_mov_b32 s33, 4098
    s_add_u32 s29, s39, 8256
    s_mov_b32 m0, s29
    s_nop 0
    buffer_load_dwordx4 v8, s[16:19], s33 offen sc1 lds
    s_mov_b64 exec, -1
    s_mov_b32 s33, 3072
    s_add_u32 s29, s39, 3072
    s_mov_b32 m0, s29
    s_nop 0
    buffer_load_dwordx4 v8, s[16:19], s33 offen sc1 lds
    s_mov_b32 s33, 3074
    s_add_u32 s29, s39, 7232
    s_mov_b32 m0, s29
    s_nop 0
    buffer_load_dwordx4 v8, s[16:19], s33 offen sc1 lds
    s_mov_b32 s33, 2048
    s_add_u32 s29, s39, 2048
    s_mov_b32 m0, s29
    s_nop 0
    buffer_load_dwordx4 v8, s[16:19], s33 offen sc1 lds
    s_mov_b32 s33, 2050
    s_add_u32 s29, s39, 6208
    s_mov_b32 m0, s29
    s_nop 0
    buffer_load_dwordx4 v8, s[16:19], s33 offen sc1 lds
    s_cmp_eq_u32 s101, 0
    s_cbranch_scc1 L_cu_147
    s_mov_b32 s33, 1024
    s_add_u32 s29, s39, 1024
    s_mov_b32 m0, s29
    s_nop 0
    buffer_load_dwordx4 v8, s[16:19], s33 offen sc1 lds
    s_mov_b32 s33, 1026
    s_add_u32 s29, s39, 5184
    s_mov_b32 m0, s29
    s_nop 0
    buffer_load_dwordx4 v8, s[16:19], s33 offen sc1 lds
    s_mov_b32 s33, 0
    s_mov_b32 m0, s39
    s_nop 0
    buffer_load_dwordx4 v8, s[16:19], s33 offen sc1 lds
    s_mov_b32 s33, 2
    s_add_u32 s29, s39, 4160
    s_mov_b32 m0, s29
    s_nop 0
    buffer_load_dwordx4 v8, s[16:19], s33 offen sc1 lds
L_cu_147:
    s_sub_u32 s94, s94, 1
    s_cmp_eq_u32 s94, 0
    s_cbranch_scc1 L_h_run
    s_add_u32 s3, s3, 1
    s_mov_b32 s39, 141824
    s_branch L_h_prep
L_h_run:
    v_swap_b32 v106, v107
    v_and_b32 v11, 15, v1
    v_lshrrev_b32 v12, 4, v1
    v_or_b32 v13, 1, v11
    v_lshlrev_b32 v13, 1, v13
    v_lshl_add_u32 v13, v12, 4, v13
    s_add_u32 s29, s39, 3598
    v_sub_u32 v100, s29, v13
    v_and_b32 v13, 1, v11
    v_xor_b32 v13, 1, v13
    v_mul_u32_u24 v13, 4160, v13
    v_add_u32 v100, v100, v13
    v_subrev_u32 v101, 1024, v100
    v_subrev_u32 v102, 2048, v100
    v_subrev_u32 v103, 3072, v100
    v_lshlrev_b32 v13, 5, v11
    v_lshlrev_b32 v14, 4, v12
    v_sub_u32 v14, v13, v14
    s_add_u32 s29, s39, 8848
    v_add_u32 v104, s29, v14
    v_mov_b32 v16, 0
    v_mov_b32 v17, 0
    v_mov_b32 v18, 0
    v_mov_b32 v19, 0
    v_mov_b32 v20, 0
    v_mov_b32 v21, 0
    v_mov_b32 v22, 0
    v_mov_b32 v23, 0
    v_mov_b32 v24, 0
    v_mov_b32 v25, 0
    v_mov_b32 v26, 0
    v_mov_b32 v27, 0
    v_mov_b32 v28, 0
    v_mov_b32 v29, 0
    v_mov_b32 v30, 0
    v_mov_b32 v31, 0
    s_waitcnt vmcnt(0)
    s_setprio 2
    s_cmp_eq_u32 s101, 0
    s_cbranch_scc1 L_clo_148
    ds_read2_b32 v[32:33], v100 offset0:128 offset1:129
    ds_read2_b32 v[34:35], v100 offset0:130 offset1:131
    ds_read_b128 v[64:67], v104 offset:0
    ds_read2_b32 v[36:37], v100 offset0:0 offset1:1
    ds_read2_b32 v[38:39], v100 offset0:2 offset1:3
    ds_read_b128 v[68:71], v104 offset:512
    ds_read2_b32 v[40:41], v101 offset0:128 offset1:129
    ds_read2_b32 v[42:43], v101 offset0:130 offset1:131
    ds_read_b128 v[72:75], v104 offset:1024
    ds_read2_b32 v[44:45], v101 offset0:0 offset1:1
    ds_read2_b32 v[46:47], v101 offset0:2 offset1:3
    ds_read_b128 v[76:79], v104 offset:1536
    s_waitcnt lgkmcnt(0)
    ds_read2_b32 v[48:49], v102 offset0:128 offset1:129
    ds_read2_b32 v[50:51], v102 offset0:130 offset1:131
    ds_read_b128 v[80:83], v104 offset:2048
    ds_read2_b32 v[52:53], v102 offset0:0 offset1:1
    ds_read2_b32 v[54:55], v102 offset0:2 offset1:3
    ds_read_b128 v[84:87], v104 offset:2560
    ds_read2_b32 v[56:57], v103 offset0:128 offset1:129
    ds_read2_b32 v[58:59], v103 offset0:130 offset1:131
    ds_read_b128 v[88:91], v104 offset:3072
    ds_read2_b32 v[60:61], v103 offset0:0 offset1:1
    ds_read2_b32 v[62:63], v103 offset0:2 offset1:3
    ds_read_b128 v[92:95], v104 offset:3584
    s_waitcnt lgkmcnt(0)
    v_subrev_u32 v100, 64, v100
    v_subrev_u32 v101, 64, v101
    v_subrev_u32 v102, 64, v102
    v_subrev_u32 v103, 64, v103
    v_subrev_u32 v104, 64, v104
    s_mov_b32 s100, 8
L_cl_150:
    s_waitcnt lgkmcnt(12)
    v_mfma_f32_16x16x32_bf16 v[16:19], v[32:35], v[80:83], v[16:19]
    v_mfma_f32_16x16x32_bf16 v[20:23], v[32:35], v[84:87], v[20:23]
    v_mfma_f32_16x16x32_bf16 v[24:27], v[32:35], v[88:91], v[24:27]
    v_mfma_f32_16x16x32_bf16 v[28:31], v[32:35], v[92:95], v[28:31]
    ds_read2_b32 v[32:33], v100 offset0:128 offset1:129
    ds_read2_b32 v[34:35], v100 offset0:130 offset1:131
    s_waitcnt lgkmcnt(9)
    ds_read_b128 v[92:95], v104 offset:3584
    v_mfma_f32_16x16x32_bf16 v[16:19], v[36:39], v[76:79], v[16:19]
    v_mfma_f32_16x16x32_bf16 v[20:23], v[36:39], v[80:83], v[20:23]
    v_mfma_f32_16x16x32_bf16 v[24:27], v[36:39], v[84:87], v[24:27]
    v_mfma_f32_16x16x32_bf16 v[28:31], v[36:39], v[88:91], v[28:31]
    ds_read2_b32 v[36:37], v100 offset0:0 offset1:1
    ds_read2_b32 v[38:39], v100 offset0:2 offset1:3
    ds_read_b128 v[88:91], v104 offset:3072
    s_waitcnt lgkmcnt(9)
    v_mfma_f32_16x16x32_bf16 v[16:19], v[40:43], v[72:75], v[16:19]
    v_mfma_f32_16x16x32_bf16 v[20:23], v[40:43], v[76:79], v[20:23]
    v_mfma_f32_16x16x32_bf16 v[24:27], v[40:43], v[80:83], v[24:27]
    v_mfma_f32_16x16x32_bf16 v[28:31], v[40:43], v[84:87], v[28:31]
    ds_read2_b32 v[40:41], v101 offset0:128 offset1:129
    ds_read2_b32 v[42:43], v101 offset0:130 offset1:131
    ds_read_b128 v[84:87], v104 offset:2560
    v_mfma_f32_16x16x32_bf16 v[16:19], v[44:47], v[68:71], v[16:19]
    v_mfma_f32_16x16x32_bf16 v[20:23], v[44:47], v[72:75], v[20:23]
    v_mfma_f32_16x16x32_bf16 v[24:27], v[44:47], v[76:79], v[24:27]
    v_mfma_f32_16x16x32_bf16 v[28:31], v[44:47], v[80:83], v[28:31]
    ds_read2_b32 v[44:45], v101 offset0:0 offset1:1
    ds_read2_b32 v[46:47], v101 offset0:2 offset1:3
    s_waitcnt lgkmcnt(9)
    ds_read_b128 v[80:83], v104 offset:2048
    v_mfma_f32_16x16x32_bf16 v[16:19], v[48:51], v[64:67], v[16:19]
    v_mfma_f32_16x16x32_bf16 v[20:23], v[48:51], v[68:71], v[20:23]
    v_mfma_f32_16x16x32_bf16 v[24:27], v[48:51], v[72:75], v[24:27]
    v_mfma_f32_16x16x32_bf16 v[28:31], v[48:51], v[76:79], v[28:31]
    ds_read2_b32 v[48:49], v102 offset0:128 offset1:129
    ds_read2_b32 v[50:51], v102 offset0:130 offset1:131
    ds_read_b128 v[76:79], v104 offset:1536
    s_waitcnt lgkmcnt(9)
    v_mfma_f32_16x16x32_bf16 v[20:23], v[52:55], v[64:67], v[20:23]
    v_mfma_f32_16x16x32_bf16 v[24:27], v[52:55], v[68:71], v[24:27]
    v_mfma_f32_16x16x32_bf16 v[28:31], v[52:55], v[72:75], v[28:31]
    ds_read2_b32 v[52:53], v102 offset0:0 offset1:1
    ds_read2_b32 v[54:55], v102 offset0:2 offset1:3
    ds_read_b128 v[72:75], v104 offset:1024
    v_mfma_f32_16x16x32_bf16 v[24:27], v[56:59], v[64:67], v[24:27]
    v_mfma_f32_16x16x32_bf16 v[28:31], v[56:59], v[68:71], v[28:31]
    ds_read2_b32 v[56:57], v103 offset0:128 offset1:129
    ds_read2_b32 v[58:59], v103 offset0:130 offset1:131
    s_waitcnt lgkmcnt(9)
    ds_read_b128 v[68:71], v104 offset:512
    v_mfma_f32_16x16x32_bf16 v[28:31], v[60:63], v[64:67], v[28:31]
    ds_read2_b32 v[60:61], v103 offset0:0 offset1:1
    ds_read2_b32 v[62:63], v103 offset0:2 offset1:3
    ds_read_b128 v[64:67], v104 offset:0
    s_waitcnt lgkmcnt(9)
    v_subrev_u32 v100, 64, v100
    v_subrev_u32 v101, 64, v101
    v_subrev_u32 v102, 64, v102
    v_subrev_u32 v103, 64, v103
    v_subrev_u32 v104, 64, v104
    s_sub_u32 s100, s100, 1
    s_cmp_lg_u32 s100, 0
    s_cbranch_scc1 L_cl_150
    s_branch L_clj_149
L_clo_148:
    ds_read2_b32 v[32:33], v100 offset0:128 offset1:129
    ds_read2_b32 v[34:35], v100 offset0:130 offset1:131
    ds_read_b128 v[64:67], v104 offset:0
    ds_read2_b32 v[36:37], v100 offset0:0 offset1:1
    ds_read2_b32 v[38:39], v100 offset0:2 offset1:3
    ds_read_b128 v[68:71], v104 offset:512
    ds_read2_b32 v[40:41], v101 offset0:128 offset1:129
    ds_read2_b32 v[42:43], v101 offset0:130 offset1:131
    ds_read_b128 v[72:75], v104 offset:1024
    ds_read2_b32 v[44:45], v101 offset0:0 offset1:1
    ds_read2_b32 v[46:47], v101 offset0:2 offset1:3
    ds_read_b128 v[76:79], v104 offset:1536
    s_waitcnt lgkmcnt(0)
    v_subrev_u32 v100, 64, v100
    v_subrev_u32 v101, 64, v101
    v_subrev_u32 v104, 64, v104
    s_mov_b32 s100, 8
L_cl_151:
    s_waitcnt lgkmcnt(0)
    v_mfma_f32_16x16x32_bf16 v[16:19], v[32:35], v[64:67], v[16:19]
    v_mfma_f32_16x16x32_bf16 v[20:23], v[32:35], v[68:71], v[20:23]
    v_mfma_f32_16x16x32_bf16 v[24:27], v[32:35], v[72:75], v[24:27]
    v_mfma_f32_16x16x32_bf16 v[28:31], v[32:35], v[76:79], v[28:31]
    ds_read2_b32 v[32:33], v100 offset0:128 offset1:129
    ds_read2_b32 v[34:35], v100 offset0:130 offset1:131
    ds_read_b128 v[76:79], v104 offset:1536
    v_mfma_f32_16x16x32_bf16 v[20:23], v[36:39], v[64:67], v[20:23]
    v_mfma_f32_16x16x32_bf16 v[24:27], v[36:39], v[68:71], v[24:27]
    v_mfma_f32_16x16x32_bf16 v[28:31], v[36:39], v[72:75], v[28:31]
    ds_read2_b32 v[36:37], v100 offset0:0 offset1:1
    ds_read2_b32 v[38:39], v100 offset0:2 offset1:3
    ds_read_b128 v[72:75], v104 offset:1024
    v_mfma_f32_16x16x32_bf16 v[24:27], v[40:43], v[64:67], v[24:27]
    v_mfma_f32_16x16x32_bf16 v[28:31], v[40:43], v[68:71], v[28:31]
    ds_read2_b32 v[40:41], v101 offset0:128 offset1:129
    ds_read2_b32 v[42:43], v101 offset0:130 offset1:131
    ds_read_b128 v[68:71], v104 offset:512
    v_mfma_f32_16x16x32_bf16 v[28:31], v[44:47], v[64:67], v[28:31]
    ds_read2_b32 v[44:45], v101 offset0:0 offset1:1
    ds_read2_b32 v[46:47], v101 offset0:2 offset1:3
    ds_read_b128 v[64:67], v104 offset:0
    v_subrev_u32 v100, 64, v100
    v_subrev_u32 v101, 64, v101
    v_subrev_u32 v104, 64, v104
    s_sub_u32 s100, s100, 1
    s_cmp_lg_u32 s100, 0
    s_cbranch_scc1 L_cl_151
L_clj_149:
    s_setprio 3
    v_lshl_add_u32 v13, v12, 3, v13
    s_lshl_b32 s32, s101, 11
    s_add_u32 s29, s39, 2552
    s_sub_u32 s29, s29, s32
    v_sub_u32 v14, s29, v13
    s_waitcnt lgkmcnt(0)
    ds_read_b64 v[32:33], v14 offset:1536
    ds_read_b64 v[34:35], v14 offset:1024
    ds_read_b64 v[36:37], v14 offset:512
    ds_read_b64 v[38:39], v14 offset:0
    s_lshl_b32 s29, s3, 12
    s_add_u32 s29, s29, s32
    s_add_u32 s29, s29, 4980736
    v_lshlrev_b32 v106, 16, v106
    s_mov_b32 s95, 0xffff0000
    s_waitcnt lgkmcnt(0)
    v_and_b32 v40, s95, v33
    v_lshlrev_b32 v41, 16, v33
    v_and_b32 v42, s95, v32
    v_lshlrev_b32 v43, 16, v32
    v_fmac_f32 v16, v40, v106
    v_fmac_f32 v17, v41, v106
    v_fmac_f32 v18, v42, v106
    v_fmac_f32 v19, v43, v106
    v_cvt_pk_bf16_f32 v32, v16, v17
    v_cvt_pk_bf16_f32 v33, v18, v19
    buffer_store_dwordx2 v[32:33], v13, s[12:15], s29 offen offset:0 sc1
    v_and_b32 v40, s95, v35
    v_lshlrev_b32 v41, 16, v35
    v_and_b32 v42, s95, v34
    v_lshlrev_b32 v43, 16, v34
    v_fmac_f32 v20, v40, v106
    v_fmac_f32 v21, v41, v106
    v_fmac_f32 v22, v42, v106
    v_fmac_f32 v23, v43, v106
    v_cvt_pk_bf16_f32 v34, v20, v21
    v_cvt_pk_bf16_f32 v35, v22, v23
    buffer_store_dwordx2 v[34:35], v13, s[12:15], s29 offen offset:512 sc1
    v_and_b32 v40, s95, v37
    v_lshlrev_b32 v41, 16, v37
    v_and_b32 v42, s95, v36
    v_lshlrev_b32 v43, 16, v36
    v_fmac_f32 v24, v40, v106
    v_fmac_f32 v25, v41, v106
    v_fmac_f32 v26, v42, v106
    v_fmac_f32 v27, v43, v106
    v_cvt_pk_bf16_f32 v36, v24, v25
    v_cvt_pk_bf16_f32 v37, v26, v27
    buffer_store_dwordx2 v[36:37], v13, s[12:15], s29 offen offset:1024 sc1
    v_and_b32 v40, s95, v39
    v_lshlrev_b32 v41, 16, v39
    v_and_b32 v42, s95, v38
    v_lshlrev_b32 v43, 16, v38
    v_fmac_f32 v28, v40, v106
    v_fmac_f32 v29, v41, v106
    v_fmac_f32 v30, v42, v106
    v_fmac_f32 v31, v43, v106
    v_cvt_pk_bf16_f32 v38, v28, v29
    v_cvt_pk_bf16_f32 v39, v30, v31
    buffer_store_dwordx2 v[38:39], v13, s[12:15], s29 offen offset:1536 sc1
    s_mul_i32 s32, s101, 576
    s_add_u32 s32, s32, s3
    s_lshl_b32 s32, s32, 4
    s_add_u32 s32, s32, 225280
    s_waitcnt vmcnt(0)
    s_mov_b64 exec, 3
    buffer_store_dwordx2 v[162:163], v9, s[12:15], s32 offen sc1
    s_mov_b64 exec, -1
    s_sub_u32 s28, s28, 1
    s_cmp_eq_u32 s28, 0
    s_cbranch_scc1 L_h_convdone
    s_sub_u32 s3, s3, 1
    s_mul_i32 s39, s23, 16512
    s_add_u32 s39, s39, 77824
    s_branch L_h_run
L_h_convdone:
    s_cmp_eq_u32 s23, 3
    s_cselect_b32 s29, 16, 1
    v_mov_b32 v11, s29
    s_mov_b64 exec, 1
    ds_add_u32 v160, v11 offset:36
    s_mov_b64 exec, -1
    s_mul_i32 s74, s25, 73728
    s_add_u32 s74, s74, s75
    s_lshl_b32 s29, s25, 8
    s_add_u32 s29, s29, 7340032
    v_lshlrev_b32 v11, 2, v164
    buffer_load_dword v165, v11, s[12:15], s29 offen sc1
    s_cmp_eq_u32 s23, 3
    s_cbranch_scc1 L_h_wodone
    s_mov_b32 s93, 0
    s_branch L_cwe_154
L_cw_152:
    s_sleep 16
L_cwe_154:
    ds_read_b32 v15, v160 offset:24
    s_add_u32 s93, s93, 1
    s_waitcnt lgkmcnt(0)
    v_readfirstlane_b32 s100, v15
    s_cmp_ge_u32 s93, 1280000
    s_cbranch_scc1 L_cwd_153
    s_cmp_lt_u32 s100, 48
    s_cbranch_scc1 L_cw_152
L_cwd_153:
    s_mov_b32 s93, 0
    s_branch L_cwe_157
L_cw_155:
    s_sleep 8
L_cwe_157:
    ds_read_b32 v15, v160 offset:36
    s_add_u32 s93, s93, 1
    s_waitcnt lgkmcnt(0)
    v_readfirstlane_b32 s100, v15
    s_cmp_ge_u32 s93, 1280000
    s_cbranch_scc1 L_cwd_156
    s_and_b32 s100, s100, 15
    s_cmp_lt_u32 s100, 3
    s_cbranch_scc1 L_cw_155
L_cwd_156:
    s_mov_b32 s32, s75
    s_lshl_b32 s39, s23, 10
    s_add_u32 s39, s39, 77824
    s_mov_b32 s33, 0
L_h_wo:
    s_cmp_lg_u32 s33, 5
    s_cbranch_scc1 L_hw5_158
    s_mov_b32 s93, 0
    s_branch L_cwe_161
L_cw_159:
    s_sleep 8
L_cwe_161:
    ds_read_b32 v15, v160 offset:36
    s_add_u32 s93, s93, 1
    s_waitcnt lgkmcnt(0)
    v_readfirstlane_b32 s100, v15
    s_cmp_ge_u32 s93, 1280000
    s_cbranch_scc1 L_cwd_160
    s_cmp_lt_u32 s100, 19
    s_cbranch_scc1 L_cw_159
L_cwd_160:
L_hw5_158:
    s_mov_b32 m0, s39
    s_nop 0
    buffer_load_dwordx4 v2, s[80:83], s32 offen lds
    s_add_u32 s29, s39, 3072
    s_mov_b32 m0, s29
    s_nop 0
    buffer_load_dwordx4 v4, s[80:83], s32 offen lds
    s_add_u32 s29, s39, 6144
    s_mov_b32 m0, s29
    s_nop 0
    buffer_load_dwordx4 v6, s[80:83], s32 offen lds
    s_add_u32 s32, s32, 82944
    s_add_u32 s39, s39, 9216
    s_add_u32 s33, s33, 1
    s_cmp_lt_u32 s33, 8
    s_cbranch_scc1 L_h_wo
    s_mov_b32 m0, s39
    s_nop 0
    buffer_load_dwordx4 v3, s[80:83], s75 offen lds
    s_add_u32 s29, s39, 3072
    s_mov_b32 m0, s29
    s_nop 0
    buffer_load_dwordx4 v5, s[80:83], s75 offen lds
    s_add_u32 s29, s39, 6144
    s_mov_b32 m0, s29
    s_nop 0
    buffer_load_dwordx4 v7, s[80:83], s75 offen lds
L_h_wodone:
    s_mov_b32 s93, 0
    s_branch L_cwe_164
L_cw_162:
    s_sleep 16
L_cwe_164:
    ds_read_b32 v15, v160 offset:24
    s_add_u32 s93, s93, 1
    s_waitcnt lgkmcnt(0)
    v_readfirstlane_b32 s100, v15
    s_cmp_ge_u32 s93, 1280000
    s_cbranch_scc1 L_cwd_163
    s_cmp_lt_u32 s100, 56
    s_cbranch_scc1 L_cw_162
L_cwd_163:
    s_mov_b32 s100, s23
L_h_xl:
    s_mul_i32 s39, s100, 1008
    s_mul_i32 s32, s100, 8064
    s_add_u32 s32, s32, s74
    s_cmp_eq_u32 s100, 9
    s_cselect_b32 exec_lo, 0x1ff, -1
    s_cselect_b32 exec_hi, 0, -1
    s_mov_b32 m0, s39
    s_nop 0
    buffer_load_dwordx4 v166, s[76:79], s32 offen lds
    s_mov_b64 exec, -1
    s_add_u32 s100, s100, 4
    s_cmp_lt_u32 s100, 10
    s_cbranch_scc1 L_h_xl
    s_cmp_lg_u32 s23, 2
    s_cbranch_scc1 L_hz_165
    s_lshr_b32 s95, s25, 4
    s_mul_i32 s95, s95, 576
    s_mul_i32 s33, s26, 72
    s_add_u32 s95, s95, s33
    s_lshl_b32 s95, s95, 4
    s_add_u32 s95, s95, 225280
    s_mov_b32 s93, 0
L_pf_167:
    buffer_load_dwordx2 v[152:153], v8, s[12:15], s95 offen offset:0 sc1
    buffer_load_dwordx2 v[154:155], v8, s[12:15], s95 offen offset:128 sc1
    s_add_u32 s93, s93, 1
    s_waitcnt vmcnt(0)
    s_cmp_lg_u32 s93, 1
    s_cbranch_scc1 L_hk_169
    s_mov_b64 exec, 1
    ds_add_u32 v160, v161 offset:40
    s_mov_b64 exec, -1
L_hk_169:
    v_cmp_ne_u64 vcc, v[152:153], v[162:163]
    v_cmp_ne_u64 s[98:99], v[154:155], v[162:163]
    s_nop 4
    s_or_b64 vcc, vcc, s[98:99]
    s_nop 4
    s_cbranch_vccz L_pfd_168
    s_sleep 16
    s_cmp_lt_u32 s93, 20000
    s_cbranch_scc1 L_pf_167
L_pfd_168:
    v_lshrrev_b32 v11, 3, v1
    v_and_b32 v12, 7, v1
    v_lshlrev_b32 v11, 12, v11
    v_lshl_add_u32 v11, v12, 4, v11
    s_mul_i32 s33, s26, 294912
    s_lshl_b32 s29, s25, 7
    s_add_u32 s33, s33, s29
    s_add_u32 s33, s33, 4980736
    s_mov_b32 s100, 0
L_zl_170:
    s_lshl_b32 s39, s100, 10
    s_lshl_b32 s32, s100, 15
    s_add_u32 s32, s32, s33
    s_add_u32 s29, s39, 9216
    s_mov_b32 m0, s29
    s_nop 0
    buffer_load_dwordx4 v11, s[12:15], s32 offen sc1 lds
    s_add_u32 s100, s100, 1
    s_cmp_lt_u32 s100, 9
    s_cbranch_scc1 L_zl_170
    s_branch L_hze_166
L_hz_165:
    s_waitcnt vmcnt(0)
    s_mov_b64 exec, 1
    ds_add_u32 v160, v161 offset:40
    s_mov_b64 exec, -1
L_hze_166:
    s_mov_b32 s93, 0
    s_branch L_cwe_173
L_cw_171:
    s_sleep 8
L_cwe_173:
    ds_read_b32 v15, v160 offset:40
    s_add_u32 s93, s93, 1
    s_waitcnt lgkmcnt(0)
    v_readfirstlane_b32 s100, v15
    s_cmp_ge_u32 s93, 1280000
    s_cbranch_scc1 L_cwd_172
    s_cmp_lt_u32 s100, 4
    s_cbranch_scc1 L_cw_171
L_cwd_172:
    v_lshrrev_b32 v11, 4, v1
    v_bfe_u32 v13, v1, 2, 2
    v_and_b32 v14, 1, v1
    v_mul_u32_u24 v12, 1152, v11
    v_lshl_add_u32 v12, v13, 4, v12
    v_lshl_add_u32 v22, v14, 3, v12
    v_add_u32 v22, 78336, v22
    v_add_u32 v23, 41472, v22
    ds_read_b64_tr_b16 v[72:73], v22 offset:0
    ds_read_b64_tr_b16 v[74:75], v22 offset:576
    ds_read_b64_tr_b16 v[76:77], v22 offset:4608
    ds_read_b64_tr_b16 v[78:79], v22 offset:5184
    ds_read_b64_tr_b16 v[80:81], v22 offset:9216
    ds_read_b64_tr_b16 v[82:83], v22 offset:9792
    ds_read_b64_tr_b16 v[84:85], v22 offset:13824
    ds_read_b64_tr_b16 v[86:87], v22 offset:14400
    ds_read_b64_tr_b16 v[88:89], v22 offset:18432
    ds_read_b64_tr_b16 v[90:91], v22 offset:19008
    ds_read_b64_tr_b16 v[92:93], v22 offset:23040
    ds_read_b64_tr_b16 v[94:95], v22 offset:23616
    s_waitcnt lgkmcnt(2)
    ds_read_b64_tr_b16 v[96:97], v22 offset:27648
    ds_read_b64_tr_b16 v[98:99], v22 offset:28224
    ds_read_b64_tr_b16 v[100:101], v22 offset:32256
    ds_read_b64_tr_b16 v[102:103], v22 offset:32832
    ds_read_b64_tr_b16 v[104:105], v22 offset:36864
    ds_read_b64_tr_b16 v[106:107], v22 offset:37440
    ds_read_b64_tr_b16 v[108:109], v23 offset:0
    ds_read_b64_tr_b16 v[110:111], v23 offset:576
    ds_read_b64_tr_b16 v[112:113], v23 offset:4608
    ds_read_b64_tr_b16 v[114:115], v23 offset:5184
    ds_read_b64_tr_b16 v[116:117], v23 offset:9216
    ds_read_b64_tr_b16 v[118:119], v23 offset:9792
    s_waitcnt lgkmcnt(2)
    ds_read_b64_tr_b16 v[120:121], v23 offset:13824
    ds_read_b64_tr_b16 v[122:123], v23 offset:14400
    ds_read_b64_tr_b16 v[124:125], v23 offset:18432
    ds_read_b64_tr_b16 v[126:127], v23 offset:19008
    ds_read_b64_tr_b16 v[128:129], v23 offset:23040
    ds_read_b64_tr_b16 v[130:131], v23 offset:23616
    ds_read_b64_tr_b16 v[132:133], v23 offset:27648
    ds_read_b64_tr_b16 v[134:135], v23 offset:28224
    ds_read_b64_tr_b16 v[136:137], v23 offset:32256
    ds_read_b64_tr_b16 v[138:139], v23 offset:32832
    ds_read_b64_tr_b16 v[140:141], v23 offset:36864
    ds_read_b64_tr_b16 v[142:143], v23 offset:37440
    s_waitcnt lgkmcnt(2)
    v_lshrrev_b32 v11, 5, v1
    v_bfe_u32 v12, v1, 4, 1
    v_and_b32 v13, 31, v164
    v_lshl_add_u32 v13, v12, 5, v13
    v_lshlrev_b32 v13, 4, v13
    v_lshl_add_u32 v13, v11, 10, v13
    v_lshrrev_b32 v14, 5, v164
    v_mul_u32_u24 v14, 36864, v14
    v_add_u32 v23, v13, v14
    v_add_u32 v23, 77824, v23
    s_mov_b32 s94, 0
    s_waitcnt vmcnt(0) lgkmcnt(0)
    s_mov_b64 exec, 1
    ds_add_u32 v160, v161 offset:8
    s_mov_b64 exec, -1
    s_lshl_b32 s95, s25, 10
    s_add_u32 s95, s95, 163840
    s_cmp_eq_u32 s23, 1
    s_cbranch_scc1 L_n1_174
    s_cmp_lg_u32 s23, 0
    s_cbranch_scc1 L_nj_175
    v_and_b32 v11, 7, v1
    v_lshlrev_b32 v11, 7, v11
    s_mov_b32 s93, 0
    s_branch L_cwe_178
L_cw_176:
    s_sleep 8
L_cwe_178:
    ds_read_b32 v15, v160 offset:24
    s_add_u32 s93, s93, 1
    s_waitcnt lgkmcnt(0)
    v_readfirstlane_b32 s100, v15
    s_cmp_ge_u32 s93, 1280000
    s_cbranch_scc1 L_cwd_177
    s_cmp_lt_u32 s100, 70
    s_cbranch_scc1 L_cw_176
L_cwd_177:
    s_mov_b32 s93, 0
L_op_179:
    buffer_load_dwordx2 v[154:155], v11, s[12:15], s95 offen sc1
    s_add_u32 s93, s93, 1
    s_waitcnt vmcnt(0)
    v_cmp_eq_u64 vcc, v[154:155], v[162:163]
    s_nop 4
    s_and_b32 s100, vcc_lo, 0xff
    s_cmp_ge_u32 s93, 20000
    s_cselect_b32 s100, 0xff, s100
    v_mov_b32 v12, s100
    ds_write_b32 v160, v12 offset:12
    s_cmp_eq_u32 s100, 0xff
    s_cbranch_scc1 L_nj_175
    s_sleep 2
    s_branch L_op_179
L_n1_174:
    s_lshl_b32 s33, s26, 7
    s_add_u32 s33, s33, s95
    s_mov_b32 s93, 0
    s_branch L_cwe_182
L_cw_180:
    s_sleep 8
L_cwe_182:
    ds_read_b32 v15, v160 offset:24
    s_add_u32 s93, s93, 1
    s_waitcnt lgkmcnt(0)
    v_readfirstlane_b32 s100, v15
    s_cmp_ge_u32 s93, 1280000
    s_cbranch_scc1 L_cwd_181
    s_cmp_lt_u32 s100, 68
    s_cbranch_scc1 L_cw_180
L_cwd_181:
    s_mov_b32 s93, 0
    s_branch L_cwe_185
L_cw_183:
    s_sleep 1
L_cwe_185:
    ds_read_b32 v15, v160 offset:44
    s_add_u32 s93, s93, 1
    s_waitcnt lgkmcnt(0)
    v_readfirstlane_b32 s100, v15
    s_cmp_ge_u32 s93, 1280000
    s_cbranch_scc1 L_cwd_184
    s_cmp_lt_u32 s100, 8
    s_cbranch_scc1 L_cw_183
L_cwd_184:
    s_mov_b64 exec, 3
    buffer_store_dwordx2 v[162:163], v9, s[12:15], s33 offen sc1
    s_mov_b64 exec, -1
L_nj_175:
    s_mov_b32 s93, 0
    s_branch L_cwe_188
L_cw_186:
    s_sleep 4
L_cwe_188:
    ds_read_b32 v15, v160 offset:8
    s_add_u32 s93, s93, 1
    s_waitcnt lgkmcnt(0)
    v_readfirstlane_b32 s100, v15
    s_cmp_ge_u32 s93, 1280000
    s_cbranch_scc1 L_cwd_187
    s_cmp_lt_u32 s100, 12
    s_cbranch_scc1 L_cw_186
L_cwd_187:
L_try_h:
    v_mov_b32 v40, 0
    v_mov_b32 v41, 0
    v_mov_b32 v42, 0
    v_mov_b32 v43, 0
    v_bfe_u32 v11, v1, 4, 1
    s_mov_b32 s33, 64
    v_mul_u32_u24 v152, 144, v164
    v_lshl_add_u32 v152, v11, 3, v152
    s_lshl_b32 s29, s33, 1
    s_add_u32 s29, s29, 0
    v_add_u32 v152, s29, v152
    v_bfe_u32 v13, v1, 2, 2
    v_lshl_add_u32 v13, v11, 2, v13
    v_lshlrev_b32 v13, 7, v13
    v_and_b32 v14, 48, v164
    v_lshl_add_u32 v13, v14, 1, v13
    v_and_b32 v14, 3, v1
    v_lshl_add_u32 v13, v14, 3, v13
    s_lshl_b32 s29, s33, 7
    s_add_u32 s29, s29, 9216
    v_add_u32 v13, s29, v13
    ds_read_b64 v[32:33], v152 offset:0
    ds_read_b64_tr_b16 v[34:35], v13 offset:0
    s_mov_b32 s95, 0xffff0000
    s_waitcnt vmcnt(0) lgkmcnt(0)
    v_sub_f32 v15, 1.0, v165
    v_cvt_pk_bf16_f32 v15, v15, v15
    v_and_b32 v15, 0xffff0000, v15
    v_lshlrev_b32 v24, 16, v32
    v_and_b32 v25, s95, v32
    v_lshlrev_b32 v28, 16, v34
    v_and_b32 v29, s95, v34
    v_lshlrev_b32 v26, 16, v33
    v_and_b32 v27, s95, v33
    v_lshlrev_b32 v30, 16, v35
    v_and_b32 v31, s95, v35
    v_mul_f32 v24, v24, v28
    v_mul_f32 v144, v15, v24
    v_mul_f32 v25, v25, v29
    v_mul_f32 v145, v15, v25
    v_mul_f32 v26, v26, v30
    v_mul_f32 v146, v15, v26
    v_mul_f32 v27, v27, v31
    v_mul_f32 v147, v15, v27
    s_barrier
    ds_read_b128 v[56:59], v23 offset:0
    ds_read_b128 v[60:63], v23 offset:2048
    ds_read_b128 v[64:67], v23 offset:4096
    ds_read_b128 v[68:71], v23 offset:6144
    s_waitcnt lgkmcnt(3)
    v_mfma_f32_16x16x32_bf16 v[40:43], v[72:75], v[56:59], v[40:43]
    ds_read_b128 v[56:59], v23 offset:8192
    s_waitcnt lgkmcnt(3)
    v_mfma_f32_16x16x32_bf16 v[40:43], v[76:79], v[60:63], v[40:43]
    ds_read_b128 v[60:63], v23 offset:10240
    s_waitcnt lgkmcnt(3)
    v_mfma_f32_16x16x32_bf16 v[40:43], v[80:83], v[64:67], v[40:43]
    ds_read_b128 v[64:67], v23 offset:12288
    s_waitcnt lgkmcnt(3)
    v_mfma_f32_16x16x32_bf16 v[40:43], v[84:87], v[68:71], v[40:43]
    ds_read_b128 v[68:71], v23 offset:14336
    s_waitcnt lgkmcnt(3)
    v_mfma_f32_16x16x32_bf16 v[40:43], v[88:91], v[56:59], v[40:43]
    ds_read_b128 v[56:59], v23 offset:16384
    s_waitcnt lgkmcnt(3)
    v_mfma_f32_16x16x32_bf16 v[40:43], v[92:95], v[60:63], v[40:43]
    ds_read_b128 v[60:63], v23 offset:18432
    s_waitcnt lgkmcnt(3)
    v_mfma_f32_16x16x32_bf16 v[40:43], v[96:99], v[64:67], v[40:43]
    ds_read_b128 v[64:67], v23 offset:20480
    s_waitcnt lgkmcnt(3)
    v_mfma_f32_16x16x32_bf16 v[40:43], v[100:103], v[68:71], v[40:43]
    ds_read_b128 v[68:71], v23 offset:22528
    s_waitcnt lgkmcnt(3)
    v_mfma_f32_16x16x32_bf16 v[40:43], v[104:107], v[56:59], v[40:43]
    ds_read_b128 v[56:59], v23 offset:24576
    s_waitcnt lgkmcnt(3)
    v_mfma_f32_16x16x32_bf16 v[40:43], v[108:111], v[60:63], v[40:43]
    ds_read_b128 v[60:63], v23 offset:26624
    s_waitcnt lgkmcnt(3)
    v_mfma_f32_16x16x32_bf16 v[40:43], v[112:115], v[64:67], v[40:43]
    ds_read_b128 v[64:67], v23 offset:28672
    s_waitcnt lgkmcnt(3)
    v_mfma_f32_16x16x32_bf16 v[40:43], v[116:119], v[68:71], v[40:43]
    ds_read_b128 v[68:71], v23 offset:30720
    s_waitcnt lgkmcnt(3)
    v_mfma_f32_16x16x32_bf16 v[40:43], v[120:123], v[56:59], v[40:43]
    ds_read_b128 v[56:59], v23 offset:32768
    s_waitcnt lgkmcnt(3)
    v_mfma_f32_16x16x32_bf16 v[40:43], v[124:127], v[60:63], v[40:43]
    ds_read_b128 v[60:63], v23 offset:34816
    s_waitcnt lgkmcnt(3)
    v_mfma_f32_16x16x32_bf16 v[40:43], v[128:131], v[64:67], v[40:43]
    s_waitcnt lgkmcnt(2)
    v_mfma_f32_16x16x32_bf16 v[40:43], v[132:135], v[68:71], v[40:43]
    s_waitcnt lgkmcnt(1)
    v_mfma_f32_16x16x32_bf16 v[40:43], v[136:139], v[56:59], v[40:43]
    s_waitcnt lgkmcnt(0)
    v_mfma_f32_16x16x32_bf16 v[40:43], v[140:143], v[60:63], v[40:43]
    s_lshl_b32 s29, s94, 2
    v_add_u32 v14, s29, v160
    s_barrier
    ds_read_b32 v15, v14 offset:128
    s_waitcnt lgkmcnt(0)
    v_readfirstlane_b32 s100, v15
    s_cmp_eq_u32 s100, 0
    s_cbranch_scc1 L_tok_189
    s_add_u32 s94, s94, 1
    s_cmp_ge_u32 s94, 16
    s_cbranch_scc1 L_tok_189
    s_sleep 8
    s_barrier
    s_branch L_try_h
L_tok_189:
    v_fmac_f32 v144, v165, v40
    v_fmac_f32 v145, v165, v41
    v_fmac_f32 v146, v165, v42
    v_fmac_f32 v147, v165, v43
    v_cvt_pk_bf16_f32 v32, v144, v145
    v_cvt_pk_bf16_f32 v33, v146, v147
    s_mov_b32 exec_hi, 0
    ds_write_b64 v152, v[32:33] offset:0
    s_mov_b32 exec_hi, -1
L_store:
    s_waitcnt lgkmcnt(0)
    s_barrier
    s_cmp_ge_u32 s24, 10
    s_cbranch_scc1 L_fin
    s_mul_i32 s29, s24, 1008
    s_add_u32 s29, s29, 0
    v_add_u32 v11, s29, v8
    ds_read_b128 v[56:59], v11
    s_mul_i32 s32, s24, 8064
    s_add_u32 s32, s32, s74
    s_cmp_eq_u32 s24, 9
    s_cselect_b32 exec_lo, 0x1ff, -1
    s_cselect_b32 exec_hi, 0, 0x7fffffff
    s_waitcnt lgkmcnt(0)
    buffer_store_dwordx4 v[56:59], v166, s[84:87], s32 offen
    s_mov_b64 exec, -1
L_fin:
L_end:
    s_endpgm
L_siteC:
    s_cmp_eq_u32 s27, 7
    s_cbranch_scc1 L_scx_190
    s_lshl_b32 s33, s27, 3
    s_add_u32 s33, s33, 8
    s_mov_b32 s93, 0
    s_branch L_cwe_194
L_cw_192:
    s_sleep 1
L_cwe_194:
    ds_read_b32 v15, v160 offset:24
    s_add_u32 s93, s93, 1
    s_waitcnt lgkmcnt(0)
    v_readfirstlane_b32 s100, v15
    s_cmp_ge_u32 s93, 1280000
    s_cbranch_scc1 L_cwd_193
    s_cmp_lt_u32 s100, s33
    s_cbranch_scc1 L_cw_192
L_cwd_193:
    s_cmp_ge_u32 s27, 3
    s_cbranch_scc1 L_scn_191
    s_lshl_b32 s29, s27, 2
    v_add_u32 v160, s29, v160
    s_and_b32 s33, s27, 1
    s_add_u32 s33, s33, 1
    s_mov_b32 s93, 0
    s_branch L_cwe_197
L_cw_195:
    s_sleep 1
L_cwe_197:
    ds_read_b32 v15, v160 offset:112
    s_add_u32 s93, s93, 1
    s_waitcnt lgkmcnt(0)
    v_readfirstlane_b32 s100, v15
    s_cmp_ge_u32 s93, 1280000
    s_cbranch_scc1 L_cwd_196
    s_cmp_lt_u32 s100, s33
    s_cbranch_scc1 L_cw_195
L_cwd_196:
    v_mov_b32 v160, 162816
L_scn_191:
    s_sub_u32 s29, s27, 1
    s_cmp_ge_u32 s29, 4
    s_cbranch_scc1 L_scx_190
    s_add_u32 s32, s27, 3
    s_add_u32 s28, s32, s72
    s_and_b32 s28, s28, 7
    s_mul_i32 s28, s28, 19456
    s_add_u32 s28, s28, 0
    s_and_b32 s38, s32, 3
    s_mul_i32 s38, s38, 19456
    s_lshl_b32 s29, s24, 10
    s_add_u32 s38, s38, s29
    s_add_u32 s28, s28, s29
    s_cmp_lt_u32 s24, 3
    s_cselect_b32 s23, 3, 2
L_scx_190:
    s_setpc_b64 s[62:63]
L_issue0:
    s_cmp_eq_u32 s36, s97
    s_cbranch_scc1 L_stx_198
    s_lshl_b32 s32, s94, 7
    s_add_u32 s32, s32, s74
    s_mov_b32 m0, s39
    s_nop 0
    buffer_load_dwordx4 v16, s[76:79], s32 offen lds
    s_add_u32 s29, s39, 1024
    s_mov_b32 m0, s29
    s_nop 0
    buffer_load_dwordx4 v17, s[76:79], s32 offen lds
L_stx_198:
    s_mul_i32 s32, s94, 73728
    s_add_u32 s32, s32, s75
    s_add_u32 s29, s39, 8192
    s_mov_b32 m0, s29
    s_nop 0
    buffer_load_dwordx4 v18, s[80:83], s32 offen lds
    s_add_u32 s29, s39, 9216
    s_mov_b32 m0, s29
    s_nop 0
    buffer_load_dwordx4 v19, s[80:83], s32 offen lds
    s_cmp_lg_u32 s36, s97
    s_cbranch_scc1 L_ste_199
    s_mov_b32 m0, s95
    s_nop 0
    buffer_load_dwordx4 v20, s[80:83], s32 offen lds
L_ste_199:
    s_add_u32 s39, s39, 17408
    s_add_u32 s95, s95, 17408
    s_add_u32 s94, s94, 1
    s_cmp_eq_u32 s94, 9
    s_cselect_b32 s94, 0, s94
    s_setpc_b64 s[62:63]
L_issue1:
    s_lshl_b32 s32, s94, 7
    s_add_u32 s32, s32, s74
    s_mov_b32 m0, s39
    s_nop 0
    buffer_load_dwordx4 v16, s[76:79], s32 offen lds
    s_add_u32 s29, s39, 1024
    s_mov_b32 m0, s29
    s_nop 0
    buffer_load_dwordx4 v17, s[76:79], s32 offen lds
L_stx_200:
    s_mul_i32 s32, s94, 73728
    s_add_u32 s32, s32, s75
    s_add_u32 s29, s39, 8192
    s_mov_b32 m0, s29
    s_nop 0
    buffer_load_dwordx4 v18, s[80:83], s32 offen lds
    s_add_u32 s29, s39, 9216
    s_mov_b32 m0, s29
    s_nop 0
    buffer_load_dwordx4 v19, s[80:83], s32 offen lds
    s_cmp_lg_u32 s36, s97
    s_cbranch_scc1 L_ste_201
    s_mov_b32 m0, s95
    s_nop 0
    buffer_load_dwordx4 v20, s[80:83], s32 offen lds
L_ste_201:
    s_add_u32 s39, s39, 17408
    s_add_u32 s95, s95, 17408
    s_add_u32 s94, s94, 1
    s_cmp_eq_u32 s94, 9
    s_cselect_b32 s94, 0, s94
    s_setpc_b64 s[62:63]
L_hconsts:
    s_sub_u32 s23, s24, 8
    s_lshl_b32 s29, s23, 6
    s_add_u32 s29, s29, 0
    s_min_u32 s29, s29, 512
    v_add_u32 v11, s29, v1
    v_mul_u32_u24 v12, 1821, v11
    v_lshrrev_b32 v12, 16, v12
    v_mul_u32_u24 v13, 36, v12
    v_sub_u32 v13, v11, v13
    v_bfe_u32 v14, v13, 2, 2
    v_and_b32 v15, 3, v13
    v_lshrrev_b32 v2, 4, v13
    v_lshlrev_b32 v2, 6, v2
    v_cmp_gt_u32 vcc, 32, v13
    v_lshl_add_u32 v13, v15, 4, v2
    s_nop 0
    v_cndmask_b32 v2, v2, v13, vcc
    v_cndmask_b32 v14, v15, v14, vcc
    v_lshl_add_u32 v12, v12, 2, v14
    v_lshrrev_b32 v13, 1, v12
    v_mul_u32_u24 v13, 18, v13
    v_and_b32 v14, 1, v12
    v_add3_u32 v13, v13, v14, 16
    v_mul_u32_u24 v13, 1152, v13
    v_add_u32 v3, v2, v13
    v_lshrrev_b32 v13, 4, v12
    v_mul_u32_u24 v13, 18, v13
    v_and_b32 v14, 3, v12
    v_add_u32 v13, v13, v14
    v_bfe_u32 v14, v12, 2, 1
    v_lshl_add_u32 v13, v14, 3, v13
    v_bfe_u32 v14, v12, 3, 1
    v_lshl_add_u32 v13, v14, 2, v13
    v_mul_u32_u24 v13, 1152, v13
    v_add_u32 v2, v2, v13
    s_lshl_b32 s29, s23, 6
    s_add_u32 s29, s29, 192
    s_min_u32 s29, s29, 512
    v_add_u32 v11, s29, v1
    v_mul_u32_u24 v12, 1821, v11
    v_lshrrev_b32 v12, 16, v12
    v_mul_u32_u24 v13, 36, v12
    v_sub_u32 v13, v11, v13
    v_bfe_u32 v14, v13, 2, 2
    v_and_b32 v15, 3, v13
    v_lshrrev_b32 v4, 4, v13
    v_lshlrev_b32 v4, 6, v4
    v_cmp_gt_u32 vcc, 32, v13
    v_lshl_add_u32 v13, v15, 4, v4
    s_nop 0
    v_cndmask_b32 v4, v4, v13, vcc
    v_cndmask_b32 v14, v15, v14, vcc
    v_lshl_add_u32 v12, v12, 2, v14
    v_lshrrev_b32 v13, 1, v12
    v_mul_u32_u24 v13, 18, v13
    v_and_b32 v14, 1, v12
    v_add3_u32 v13, v13, v14, 16
    v_mul_u32_u24 v13, 1152, v13
    v_add_u32 v5, v4, v13
    v_lshrrev_b32 v13, 4, v12
    v_mul_u32_u24 v13, 18, v13
    v_and_b32 v14, 3, v12
    v_add_u32 v13, v13, v14
    v_bfe_u32 v14, v12, 2, 1
    v_lshl_add_u32 v13, v14, 3, v13
    v_bfe_u32 v14, v12, 3, 1
    v_lshl_add_u32 v13, v14, 2, v13
    v_mul_u32_u24 v13, 1152, v13
    v_add_u32 v4, v4, v13
    s_lshl_b32 s29, s23, 6
    s_add_u32 s29, s29, 384
    s_min_u32 s29, s29, 512
    v_add_u32 v11, s29, v1
    v_mul_u32_u24 v12, 1821, v11
    v_lshrrev_b32 v12, 16, v12
    v_mul_u32_u24 v13, 36, v12
    v_sub_u32 v13, v11, v13
    v_bfe_u32 v14, v13, 2, 2
    v_and_b32 v15, 3, v13
    v_lshrrev_b32 v6, 4, v13
    v_lshlrev_b32 v6, 6, v6
    v_cmp_gt_u32 vcc, 32, v13
    v_lshl_add_u32 v13, v15, 4, v6
    s_nop 0
    v_cndmask_b32 v6, v6, v13, vcc
    v_cndmask_b32 v14, v15, v14, vcc
    v_lshl_add_u32 v12, v12, 2, v14
    v_lshrrev_b32 v13, 1, v12
    v_mul_u32_u24 v13, 18, v13
    v_and_b32 v14, 1, v12
    v_add3_u32 v13, v13, v14, 16
    v_mul_u32_u24 v13, 1152, v13
    v_add_u32 v7, v6, v13
    v_lshrrev_b32 v13, 4, v12
    v_mul_u32_u24 v13, 18, v13
    v_and_b32 v14, 3, v12
    v_add_u32 v13, v13, v14
    v_bfe_u32 v14, v12, 2, 1
    v_lshl_add_u32 v13, v14, 3, v13
    v_bfe_u32 v14, v12, 3, 1
    v_lshl_add_u32 v13, v14, 2, v13
    v_mul_u32_u24 v13, 1152, v13
    v_add_u32 v6, v6, v13
    v_mul_u32_u24 v11, 7282, v1
    v_lshrrev_b32 v11, 16, v11
    v_mul_u32_u24 v12, 9, v11
    v_sub_u32 v12, v1, v12
    v_mul_u32_u24 v11, 1152, v11
    v_lshl_add_u32 v166, v12, 4, v11
    s_and_b32 s32, s24, 1
    s_lshl_b32 s32, s32, 5
    s_sub_u32 s29, s24, 8
    s_lshl_b32 s29, s29, 4
    s_cmp_lt_u32 s24, 8
    s_cselect_b32 s32, s32, s29
    s_cselect_b32 s29, 31, 15
    v_and_b32 v164, s29, v1
    v_add_u32 v164, s32, v164
    s_setpc_b64 s[62:63]
L_fallback:
    v_mov_b32 v13, 0xff7fffff
    v_mov_b32 v72, 0
    v_mov_b32 v73, 0
    v_mov_b32 v74, 0
    v_mov_b32 v75, 0
    v_mov_b32 v76, 0
    v_mov_b32 v77, 0
    v_mov_b32 v78, 0
    v_mov_b32 v79, 0
    v_mov_b32 v80, 0
    v_mov_b32 v81, 0
    v_mov_b32 v82, 0
    v_mov_b32 v83, 0
    v_mov_b32 v84, 0
    v_mov_b32 v85, 0
    v_mov_b32 v86, 0
    v_mov_b32 v87, 0
    v_mov_b32 v14, 0xff7fffff
    v_mov_b32 v116, 0
    v_mov_b32 v117, 0
    v_mov_b32 v118, 0
    v_mov_b32 v119, 0
    v_mov_b32 v120, 0
    v_mov_b32 v121, 0
    v_mov_b32 v122, 0
    v_mov_b32 v123, 0
    v_mov_b32 v124, 0
    v_mov_b32 v125, 0
    v_mov_b32 v126, 0
    v_mov_b32 v127, 0
    v_mov_b32 v128, 0
    v_mov_b32 v129, 0
    v_mov_b32 v130, 0
    v_mov_b32 v131, 0
    v_and_b32 v4, 31, v1
    v_lshlrev_b32 v4, 3, v4
    v_mov_b32 v21, 0
    s_mov_b32 s93, 0
L_fb_loop:
    s_lshr_b32 s29, s93, 2
    s_mul_i32 s29, s29, 19456
    s_add_u32 s29, s29, 0
    s_and_b32 s32, s93, 3
    s_lshl_b32 s33, s36, 2
    s_add_u32 s32, s32, s33
    s_lshl_b32 s33, s32, 10
    s_add_u32 s33, s33, s29
    buffer_load_dwordx4 v[16:19], v8, s[12:15], s33 offen sc1
    s_lshr_b32 s33, s32, 1
    s_lshl_b32 s33, s33, 8
    s_and_b32 s95, s32, 1
    s_lshl_b32 s95, s95, 2
    s_add_u32 s33, s33, s95
    s_add_u32 s33, s33, s29
    s_add_u32 s33, s33, 8192
    buffer_load_dword v20, v4, s[12:15], s33 offen sc1
    s_mul_i32 s33, s32, 1280
    s_add_u32 s33, s33, s29
    s_add_u32 s33, s33, 9216
    buffer_load_dwordx4 v[24:27], v10, s[12:15], s33 offen sc1
    buffer_load_dwordx4 v[28:31], v10, s[12:15], s33 offen offset:640 sc1
    s_waitcnt vmcnt(0)
    v_mfma_f32_32x32x16_bf16 v[40:55], v[16:19], v[104:107], 0
    v_mfma_f32_32x32x8_bf16 v[40:55], v[20:21], v[108:109], v[40:55]
    v_mfma_f32_32x32x16_bf16 v[56:71], v[16:19], v[148:151], 0
    v_mfma_f32_32x32x8_bf16 v[56:71], v[20:21], v[152:153], v[56:71]
    s_nop 15
    v_max3_f32 v11, v40, v41, v42
    v_max_f32 v11, v11, v43
    v_max3_f32 v11, v11, v44, v45
    v_max3_f32 v11, v11, v46, v47
    v_max3_f32 v11, v11, v48, v49
    v_max3_f32 v11, v11, v50, v51
    v_max3_f32 v11, v11, v52, v53
    v_max3_f32 v11, v11, v54, v55
    v_mov_b32 v12, v11
    s_nop 1
    v_permlane32_swap_b32 v11, v12
    s_nop 1
    v_max_f32 v11, v11, v12
    v_max_f32 v11, v11, v13
    v_sub_f32 v12, v13, v11
    v_exp_f32 v12, v12
    v_mov_b32 v13, v11
    v_mul_f32 v72, v72, v12
    v_mul_f32 v73, v73, v12
    v_mul_f32 v74, v74, v12
    v_mul_f32 v75, v75, v12
    v_mul_f32 v76, v76, v12
    v_mul_f32 v77, v77, v12
    v_mul_f32 v78, v78, v12
    v_mul_f32 v79, v79, v12
    v_mul_f32 v80, v80, v12
    v_mul_f32 v81, v81, v12
    v_mul_f32 v82, v82, v12
    v_mul_f32 v83, v83, v12
    v_mul_f32 v84, v84, v12
    v_mul_f32 v85, v85, v12
    v_mul_f32 v86, v86, v12
    v_mul_f32 v87, v87, v12
    v_sub_f32 v40, v40, v11
    v_sub_f32 v41, v41, v11
    v_sub_f32 v42, v42, v11
    v_sub_f32 v43, v43, v11
    v_sub_f32 v44, v44, v11
    v_sub_f32 v45, v45, v11
    v_sub_f32 v46, v46, v11
    v_sub_f32 v47, v47, v11
    v_sub_f32 v48, v48, v11
    v_sub_f32 v49, v49, v11
    v_sub_f32 v50, v50, v11
    v_sub_f32 v51, v51, v11
    v_sub_f32 v52, v52, v11
    v_sub_f32 v53, v53, v11
    v_sub_f32 v54, v54, v11
    v_sub_f32 v55, v55, v11
    v_exp_f32 v40, v40
    v_exp_f32 v41, v41
    v_exp_f32 v42, v42
    v_exp_f32 v43, v43
    v_exp_f32 v44, v44
    v_exp_f32 v45, v45
    v_exp_f32 v46, v46
    v_exp_f32 v47, v47
    v_exp_f32 v48, v48
    v_exp_f32 v49, v49
    v_exp_f32 v50, v50
    v_exp_f32 v51, v51
    v_exp_f32 v52, v52
    v_exp_f32 v53, v53
    v_exp_f32 v54, v54
    v_exp_f32 v55, v55
    s_nop 0
    v_cvt_pk_bf16_f32 v32, v40, v41
    v_cvt_pk_bf16_f32 v33, v42, v43
    v_cvt_pk_bf16_f32 v34, v44, v45
    v_cvt_pk_bf16_f32 v35, v46, v47
    v_cvt_pk_bf16_f32 v36, v48, v49
    v_cvt_pk_bf16_f32 v37, v50, v51
    v_cvt_pk_bf16_f32 v38, v52, v53
    v_cvt_pk_bf16_f32 v39, v54, v55
    s_nop 1
    v_mfma_f32_32x32x16_bf16 v[72:87], v[24:27], v[32:35], v[72:87]
    v_mfma_f32_32x32x16_bf16 v[72:87], v[28:31], v[36:39], v[72:87]
    v_max3_f32 v11, v56, v57, v58
    v_max_f32 v11, v11, v59
    v_max3_f32 v11, v11, v60, v61
    v_max3_f32 v11, v11, v62, v63
    v_max3_f32 v11, v11, v64, v65
    v_max3_f32 v11, v11, v66, v67
    v_max3_f32 v11, v11, v68, v69
    v_max3_f32 v11, v11, v70, v71
    v_mov_b32 v12, v11
    s_nop 1
    v_permlane32_swap_b32 v11, v12
    s_nop 1
    v_max_f32 v11, v11, v12
    v_max_f32 v11, v11, v14
    v_sub_f32 v12, v14, v11
    v_exp_f32 v12, v12
    v_mov_b32 v14, v11
    v_mul_f32 v116, v116, v12
    v_mul_f32 v117, v117, v12
    v_mul_f32 v118, v118, v12
    v_mul_f32 v119, v119, v12
    v_mul_f32 v120, v120, v12
    v_mul_f32 v121, v121, v12
    v_mul_f32 v122, v122, v12
    v_mul_f32 v123, v123, v12
    v_mul_f32 v124, v124, v12
    v_mul_f32 v125, v125, v12
    v_mul_f32 v126, v126, v12
    v_mul_f32 v127, v127, v12
    v_mul_f32 v128, v128, v12
    v_mul_f32 v129, v129, v12
    v_mul_f32 v130, v130, v12
    v_mul_f32 v131, v131, v12
    v_sub_f32 v56, v56, v11
    v_sub_f32 v57, v57, v11
    v_sub_f32 v58, v58, v11
    v_sub_f32 v59, v59, v11
    v_sub_f32 v60, v60, v11
    v_sub_f32 v61, v61, v11
    v_sub_f32 v62, v62, v11
    v_sub_f32 v63, v63, v11
    v_sub_f32 v64, v64, v11
    v_sub_f32 v65, v65, v11
    v_sub_f32 v66, v66, v11
    v_sub_f32 v67, v67, v11
    v_sub_f32 v68, v68, v11
    v_sub_f32 v69, v69, v11
    v_sub_f32 v70, v70, v11
    v_sub_f32 v71, v71, v11
    v_exp_f32 v56, v56
    v_exp_f32 v57, v57
    v_exp_f32 v58, v58
    v_exp_f32 v59, v59
    v_exp_f32 v60, v60
    v_exp_f32 v61, v61
    v_exp_f32 v62, v62
    v_exp_f32 v63, v63
    v_exp_f32 v64, v64
    v_exp_f32 v65, v65
    v_exp_f32 v66, v66
    v_exp_f32 v67, v67
    v_exp_f32 v68, v68
    v_exp_f32 v69, v69
    v_exp_f32 v70, v70
    v_exp_f32 v71, v71
    s_nop 0
    v_cvt_pk_bf16_f32 v32, v56, v57
    v_cvt_pk_bf16_f32 v33, v58, v59
    v_cvt_pk_bf16_f32 v34, v60, v61
    v_cvt_pk_bf16_f32 v35, v62, v63
    v_cvt_pk_bf16_f32 v36, v64, v65
    v_cvt_pk_bf16_f32 v37, v66, v67
    v_cvt_pk_bf16_f32 v38, v68, v69
    v_cvt_pk_bf16_f32 v39, v70, v71
    s_nop 1
    v_mfma_f32_32x32x16_bf16 v[116:131], v[24:27], v[32:35], v[116:131]
    v_mfma_f32_32x32x16_bf16 v[116:131], v[28:31], v[36:39], v[116:131]
    s_nop 15
    s_add_u32 s93, s93, 1
    s_cmp_lt_u32 s93, 32
    s_cbranch_scc1 L_fb_loop
    v_sub_f32 v88, 0, v13
    v_cndmask_b32 v82, v82, v86, s[30:31]
    v_sub_f32 v132, 0, v14
    v_cndmask_b32 v126, v126, v130, s[30:31]
    s_branch L_attn_ok
L_code_end:
    s_endpgm
.section .rodata,"a"
.p2align 6
.amdhsa_kernel gated_mix__grouped_kv_mqa__ssm_conv_h3__prompt_kernel
  .amdhsa_next_free_vgpr 168
  .amdhsa_next_free_sgpr 102
  .amdhsa_accum_offset 168
  .amdhsa_group_segment_fixed_size 0
  .amdhsa_kernarg_size 120
  .amdhsa_user_sgpr_count 2
  .amdhsa_user_sgpr_kernarg_segment_ptr 1
  .amdhsa_system_sgpr_workgroup_id_x 1
  .amdhsa_float_denorm_mode_32 3
  .amdhsa_float_denorm_mode_16_64 3
.end_amdhsa_kernel
```
